```python
import torch

def _softmax(x, axis=-1):
    return torch.softmax(x, dim=axis)
def _gelu(x):
    return torch.nn.functional.gelu(x, approximate="tanh")
def _silu(x):
    return torch.nn.functional.silu(x)
def _sigmoid(x):
    return torch.sigmoid(x)
def _layernorm(x, axis=-1, eps=1e-5):
    m = x.mean(dim=axis, keepdim=True)
    v = x.var(dim=axis, keepdim=True, unbiased=False)
    return (x - m) / torch.sqrt(v + eps)
def _scatter_add(tgt, idx, src, axis=0):
    return tgt.clone().index_add_(axis, idx, src)
def _segment_sum(src, seg, n):
    out = torch.zeros((n,) + src.shape[1:], dtype=src.dtype)
    return out.index_add_(0, seg, src)
def _pad(x, pw):
    flat = tuple(v for pair in reversed(pw) for v in pair)
    return torch.nn.functional.pad(x, flat)

kernel_name = 'parallel_sum__gqa_block_cached__geglu_ffn__decode'

def setup_inputs():

    _w = (lambda a: (lambda t: t.to(torch.bfloat16) if t.is_floating_point() else t)(torch.as_tensor(a)))
    def _A_setup():
        B, Sq, D = 2, 1, 576
        Hq, Hkv, Sk, Dh = 32, 16, 32768, 128
        assert Hq % Hkv == 0, (Hq, Hkv)
        return {
            "x": _w((lambda *s: torch.randn(*s, dtype=torch.bfloat16) * 0.05)(B, Sq, D)),
            "k_cache": _w((lambda *s: torch.randn(*s, dtype=torch.bfloat16) * 3.2)(B, Hkv, Sk, Dh)),
            "v_cache": _w((lambda *s: torch.randn(*s, dtype=torch.bfloat16) * 1.6)(B, Hkv, Sk, Dh)),
            "wq": _w((lambda *s: torch.randn(*s, dtype=torch.bfloat16) * 3.2)(D, Hq * Dh) * (D ** -0.5)),
            "wo": _w((lambda *s: torch.randn(*s, dtype=torch.bfloat16) * 1.6)(Hq * Dh, D) * ((Hq * Dh) ** -0.5)),
        }
    _A_in = _A_setup()

    def _B_setup():
        B, S, D, F = 2, 1, 576, 4608
        return {
            "x": _w((lambda *s: torch.randn(*s, dtype=torch.bfloat16) * 0.05)(B, S, D)),
            "w_gate": _w((lambda *s: torch.randn(*s, dtype=torch.bfloat16) * 0.05)(D, F)),
            "w_up": _w((lambda *s: torch.randn(*s, dtype=torch.bfloat16) * 0.05)(D, F)),
            "w_down": _w((lambda *s: torch.randn(*s, dtype=torch.bfloat16) * 0.05)(F, D)),
        }
    _B_in = _B_setup()

    return {
        "A_x": _A_in["x"],
        "A_k_cache": _A_in["k_cache"],
        "A_v_cache": _A_in["v_cache"],
        "A_wq": _A_in["wq"],
        "A_wo": _A_in["wo"],
        "B_x": _B_in["x"],
        "B_w_gate": _B_in["w_gate"],
        "B_w_up": _B_in["w_up"],
        "B_w_down": _B_in["w_down"],
    }

def reference(A_x, A_k_cache, A_v_cache, A_wq, A_wo, B_x, B_w_gate, B_w_up, B_w_down):
    def _A_ref(x, k_cache, v_cache, wq, wo):
        B, Sq, D = x.shape
        Hq, Dh = 32, 128
        Hkv = k_cache.shape[1]
        rep = Hq // Hkv
        q = (lambda x, *d: x.permute(*d))((x @ wq).reshape(B, Sq, Hq, Dh), 0, 2, 1, 3)
        k = (lambda x, n, axis: torch.repeat_interleave(x, n, dim=axis))(k_cache, rep, axis=1)
        v = (lambda x, n, axis: torch.repeat_interleave(x, n, dim=axis))(v_cache, rep, axis=1)
        scores = torch.einsum("bhqd,bhkd->bhqk", q, k) * (Dh ** -0.5)
        p = _softmax(scores, axis=-1)
        o = torch.einsum("bhqk,bhkd->bhqd", p, v)
        return (lambda x, *d: x.permute(*d))(o, 0, 2, 1, 3).reshape(B, Sq, Hq * Dh) @ wo

    def _B_ref(x, w_gate, w_up, w_down):
        return (_gelu(x @ w_gate) * (x @ w_up)) @ w_down

    x = A_x
    xn = _layernorm(x, axis=-1)
    return x + _A_ref(xn, A_k_cache, A_v_cache, A_wq, A_wo) + _B_ref(xn, B_w_gate, B_w_up, B_w_down)
```

```asm
; @launch grid=(256,1,1) block=(512,1,1) lds=163840
.amdgcn_target "amdgcn-amd-amdhsa--gfx950"
.text
.globl parallel_sum__gqa_block_cached__geglu_ffn__decode_kernel
.p2align 8
.type parallel_sum__gqa_block_cached__geglu_ffn__decode_kernel,@function
parallel_sum__gqa_block_cached__geglu_ffn__decode_kernel:
    s_cmp_ge_u32 s2, 256
    s_cbranch_scc1 L_end
    s_load_dwordx16 s[4:19], s[0:1], 0
    s_load_dwordx8 s[20:27], s[0:1], 64
    s_lshr_b32 s84, s2, 3
    s_add_u32 s72, s2, s84
    s_and_b32 s72, s72, 7
    s_cmp_eq_u32 s72, 0
    s_mov_b32 s76, 0x7c0000
    s_mov_b32 s77, 0x7e0000
    s_mov_b32 s78, 0x780000
    s_mov_b32 s79, 0x7a0000
    s_cmp_eq_u32 s72, 1
    s_cselect_b32 s76, 0x7a007c, s76
    s_cselect_b32 s77, 0x78007e, s77
    s_cselect_b32 s78, 0x7b0078, s78
    s_cselect_b32 s79, 0x79007a, s79
    s_cmp_eq_u32 s72, 2
    s_cselect_b32 s76, 0x7a00f6, s76
    s_cselect_b32 s77, 0x7c00f6, s77
    s_cselect_b32 s78, 0x7a00f3, s78
    s_cselect_b32 s79, 0x7c00f3, s79
    s_cmp_eq_u32 s72, 3
    s_cselect_b32 s76, 0x7c0170, s76
    s_cselect_b32 s77, 0x7a0172, s77
    s_cselect_b32 s78, 0x7f016d, s78
    s_cselect_b32 s79, 0x7d016f, s79
    s_cmp_eq_u32 s72, 4
    s_cselect_b32 s76, 0x7d01ec, s76
    s_cselect_b32 s77, 0x7f01ec, s77
    s_cselect_b32 s78, 0x7d01ec, s78
    s_cselect_b32 s79, 0x7f01ec, s79
    s_cmp_eq_u32 s72, 5
    s_cselect_b32 s76, 0x7f0269, s76
    s_cselect_b32 s77, 0x7d026b, s77
    s_cselect_b32 s78, 0x7f0269, s78
    s_cselect_b32 s79, 0x7d026b, s79
    s_cmp_eq_u32 s72, 6
    s_cselect_b32 s76, 0x7d02e8, s76
    s_cselect_b32 s77, 0x7f02e8, s77
    s_cselect_b32 s78, 0x7d02e8, s78
    s_cselect_b32 s79, 0x7f02e8, s79
    s_cmp_eq_u32 s72, 7
    s_cselect_b32 s76, 0x7f0365, s76
    s_cselect_b32 s77, 0x7d0367, s77
    s_cselect_b32 s78, 0x7f0365, s78
    s_cselect_b32 s79, 0x7d0367, s79
    s_bitcmp1_b32 s84, 0
    s_cselect_b32 s76, s77, s76
    s_cselect_b32 s78, s79, s78
    s_cmp_lt_u32 s84, 4
    s_cselect_b32 s68, s76, s78
    s_lshl_b32 s73, s72, 5
    s_add_u32 s73, s73, s84
    s_cmp_lt_u32 s73, 100
    s_cselect_b32 s73, s73, 255
    s_lshl_b32 s74, s84, 1
    s_add_u32 s74, s74, s72
    s_cmp_lt_u32 s72, 2
    s_cselect_b32 s69, s74, s73
    s_mul_i32 s73, s84, 7
    s_add_u32 s73, s73, s72
    s_sub_u32 s73, s73, 8
    s_sub_u32 s74, s73, 1
    s_cmp_lt_u32 s72, 2
    s_cselect_b32 s73, s73, s74
    s_cmp_eq_u32 s72, 2
    s_cselect_b32 s73, 255, s73
    s_mul_i32 s74, s84, 5
    s_add_u32 s75, s74, s72
    s_sub_u32 s75, s75, 3
    s_cmp_ge_u32 s72, 4
    s_cselect_b32 s75, s75, 255
    s_cmp_eq_u32 s72, 1
    s_cselect_b32 s75, s74, s75
    s_cmp_lt_u32 s84, 4
    s_cselect_b32 s73, s75, s73
    s_lshl_b32 s73, s73, 8
    s_or_b32 s69, s69, s73
    s_sub_u32 s73, s72, 4
    s_lshl_b32 s73, s73, 5
    s_add_u32 s73, s73, s84
    s_cmp_lt_u32 s73, 72
    s_cselect_b32 s73, s73, 255
    s_lshl_b32 s73, s73, 16
    s_or_b32 s69, s69, s73
    v_lshrrev_b32 v1, 6, v0
    v_and_b32 v0, 63, v0
    v_readfirstlane_b32 s3, v1
    s_lshr_b32 s73, s2, 2
    s_and_b32 s74, s2, 3
    s_mul_i32 s75, s74, 144
    s_mul_i32 s72, s3, 18
    s_add_u32 s75, s75, s72
    v_lshrrev_b32 v152, 3, v0
    v_add_u32 v153, s75, v152
    v_and_b32 v6, 7, v0
    v_lshlrev_b32 v6, 4, v6
    v_lshl_add_u32 v154, v153, 13, v6
    v_cmp_gt_u32 vcc, 2, v152
    v_mov_b32 v155, 1073741824
    s_lshl_b32 s76, s73, 7
    v_cndmask_b32 v155, v155, v154, vcc
    s_add_u32 s77, s76, 65536
    s_add_u32 s78, s76, 131072
    v_lshrrev_b32 v156, 5, v0
    v_mul_u32_u24 v156, 1152, v156
    v_and_b32 v7, 31, v0
    v_lshl_add_u32 v156, v7, 2, v156
    v_lshrrev_b32 v150, 4, v0
    v_and_b32 v151, 15, v0
    v_and_b32 v6, 3, v0
    v_lshlrev_b32 v6, 2, v6
    v_bfe_u32 v7, v0, 2, 2
    v_add_u32 v6, v6, v7
    v_lshlrev_b32 v6, 8, v6
    v_lshl_add_u32 v1, v150, 4, v6
    v_lshlrev_b32 v2, 4, v0
    s_lshr_b32 s84, s2, 3
    s_lshl_b32 s88, s84, 23
    s_mul_i32 s85, s84, 32
    s_waitcnt lgkmcnt(0)
    s_load_dword s90, s[26:27], 0
    s_mov_b32 s28, s4
    s_mov_b32 s29, s5
    s_mov_b32 s30, 0x900
    s_mov_b32 s31, 0x20000
    s_mov_b32 s40, s10
    s_mov_b32 s41, s11
    s_mov_b32 s42, 0x480000
    s_mov_b32 s43, 0x20000
    s_cmp_eq_u32 s3, 0
    s_cbranch_scc0 L_nox
    buffer_load_dword v116, v156, s[28:31], 0 offen offset:0
    buffer_load_dword v117, v156, s[28:31], 0 offen offset:128
    buffer_load_dword v118, v156, s[28:31], 0 offen offset:256
    buffer_load_dword v119, v156, s[28:31], 0 offen offset:384
    buffer_load_dword v120, v156, s[28:31], 0 offen offset:512
    buffer_load_dword v121, v156, s[28:31], 0 offen offset:640
    buffer_load_dword v122, v156, s[28:31], 0 offen offset:768
    buffer_load_dword v123, v156, s[28:31], 0 offen offset:896
    buffer_load_dword v124, v156, s[28:31], 0 offen offset:1024
L_nox:
    buffer_load_dwordx4 v[36:39], v154, s[40:43], s76 offen nt
    buffer_load_dwordx4 v[40:43], v154, s[40:43], s77 offen nt
    buffer_load_dwordx4 v[44:47], v155, s[40:43], s78 offen nt
    s_mov_b32 s32, s6
    s_mov_b32 s33, s7
    s_mov_b32 s34, 0x10000000
    s_mov_b32 s35, 0x20000
    s_and_b32 s89, s68, 0xffff
    s_lshr_b32 s80, s68, 16
    s_add_u32 s98, s89, s3
    s_sub_u32 s98, s98, 1
    s_add_u32 s99, s98, 7
    s_cmp_eq_u32 s3, 0
    s_cbranch_scc1 L_nok0
    s_add_u32 s72, s98, s85
    s_and_b32 s72, s72, 1023
    s_lshl_b32 s72, s72, 13
    s_add_u32 s72, s72, s88
    s_cmp_lt_u32 s98, 1024
    s_cselect_b32 s94, s72, 1073741824
    s_add_u32 s95, s94, 4096
    buffer_load_dwordx4 a[0:3], v1, s[32:35], s94 offen offset:0 nt
    buffer_load_dwordx4 a[4:7], v1, s[32:35], s94 offen offset:64 nt
    buffer_load_dwordx4 a[8:11], v1, s[32:35], s94 offen offset:128 nt
    buffer_load_dwordx4 a[12:15], v1, s[32:35], s94 offen offset:192 nt
    buffer_load_dwordx4 a[16:19], v1, s[32:35], s95 offen offset:0 nt
    buffer_load_dwordx4 a[20:23], v1, s[32:35], s95 offen offset:64 nt
    buffer_load_dwordx4 a[24:27], v1, s[32:35], s95 offen offset:128 nt
    buffer_load_dwordx4 a[28:31], v1, s[32:35], s95 offen offset:192 nt
L_nok0:
    s_mov_b32 s36, s8
    s_mov_b32 s37, s9
    s_mov_b32 s38, 0x10000000
    s_mov_b32 s39, 0x20000
    s_mov_b32 s48, s16
    s_mov_b32 s49, s17
    s_mov_b32 s50, 0x510000
    s_mov_b32 s51, 0x20000
    s_mov_b32 s52, s18
    s_mov_b32 s53, s19
    s_mov_b32 s54, 0x510000
    s_mov_b32 s55, 0x20000
    s_mov_b32 s44, s12
    s_mov_b32 s45, s13
    s_mov_b32 s46, 0x480000
    s_mov_b32 s47, 0x20000
    s_mov_b32 s56, s20
    s_mov_b32 s57, s21
    s_mov_b32 s58, 0x510000
    s_mov_b32 s59, 0x20000
    s_mov_b32 s60, s22
    s_mov_b32 s61, s23
    s_mov_b32 s62, 0x900
    s_mov_b32 s63, 0x20000
    s_mov_b32 s64, s26
    s_mov_b32 s65, s27
    s_mov_b32 s66, 0x400000
    s_mov_b32 s67, 0x20000
    s_lshl_b32 s72, s84, 8
    s_add_u32 s72, s72, 16384
    s_add_u32 s70, s26, s72
    s_addc_u32 s71, s27, 0
    s_and_b32 s68, s69, 255
    s_bfe_u32 s12, s69, 0x80010
    s_bfe_u32 s69, s69, 0x80008
    s_mov_b32 s18, 0
    s_mov_b32 s19, 0x10000
    s_sub_u32 s72, s68, 64
    s_cmp_lt_u32 s72, 36
    s_cselect_b32 s19, 0, s19
    s_mov_b32 s82, 0x05040100
    s_mov_b32 s83, 0x07060302
    s_mov_b32 s86, 0x3db504f3
    s_mov_b32 s87, 0x3fb8aa3b
    v_mov_b32 v148, 6656
    v_mov_b32 v149, 1
    s_cmp_eq_u32 s3, 0
    s_cbranch_scc0 L_A0
    s_and_b32 s72, s2, 15
    s_cmp_lt_u32 s72, 2
    s_cbranch_scc0 L_noinit
    s_lshl_b32 s72, s72, 4
    s_lshr_b32 s91, s2, 4
    s_add_u32 s72, s72, s91
    s_lshl_b32 s72, s72, 8
    s_add_u32 s72, s72, 16384
    v_mov_b32 v6, 996
    v_mov_b32 v7, 0
    s_mov_b64 exec, 1
    buffer_store_dword v6, v7, s[64:67], s72 offen sc1
    s_mov_b64 exec, -1
L_noinit:
    s_waitcnt vmcnt(3)
    v_lshlrev_b32 v126, 16, v116
    v_and_b32 v127, 0xffff0000, v116
    v_lshlrev_b32 v128, 16, v117
    v_and_b32 v129, 0xffff0000, v117
    v_lshlrev_b32 v130, 16, v118
    v_and_b32 v131, 0xffff0000, v118
    v_lshlrev_b32 v132, 16, v119
    v_and_b32 v133, 0xffff0000, v119
    v_lshlrev_b32 v134, 16, v120
    v_and_b32 v135, 0xffff0000, v120
    v_lshlrev_b32 v136, 16, v121
    v_and_b32 v137, 0xffff0000, v121
    v_lshlrev_b32 v138, 16, v122
    v_and_b32 v139, 0xffff0000, v122
    v_lshlrev_b32 v140, 16, v123
    v_and_b32 v141, 0xffff0000, v123
    v_lshlrev_b32 v142, 16, v124
    v_and_b32 v143, 0xffff0000, v124
    v_add_f32 v8, v126, v127
    v_add_f32 v9, v128, v129
    v_add_f32 v8, v8, v130
    v_add_f32 v9, v9, v131
    v_add_f32 v8, v8, v132
    v_add_f32 v9, v9, v133
    v_add_f32 v8, v8, v134
    v_add_f32 v9, v9, v135
    v_add_f32 v8, v8, v136
    v_add_f32 v9, v9, v137
    v_add_f32 v8, v8, v138
    v_add_f32 v9, v9, v139
    v_add_f32 v8, v8, v140
    v_add_f32 v9, v9, v141
    v_add_f32 v8, v8, v142
    v_add_f32 v9, v9, v143
    v_add_f32 v8, v8, v9
    s_nop 1
    v_add_f32_dpp v8, v8, v8 quad_perm:[1,0,3,2] row_mask:0xf bank_mask:0xf
    s_nop 1
    v_add_f32_dpp v8, v8, v8 quad_perm:[2,3,0,1] row_mask:0xf bank_mask:0xf
    s_nop 1
    v_add_f32_dpp v8, v8, v8 row_half_mirror row_mask:0xf bank_mask:0xf
    s_nop 1
    v_add_f32_dpp v8, v8, v8 row_mirror row_mask:0xf bank_mask:0xf
    v_mov_b32 v9, v8
    s_nop 1
    v_permlane16_swap_b32 v8, v9
    s_nop 1
    v_add_f32 v8, v8, v9
    v_mul_f32 v10, 0x3ae38e39, v8
    v_sub_f32 v9, v126, v10
    v_sub_f32 v8, v127, v10
    v_mul_f32 v11, v9, v9
    v_mul_f32 v12, v8, v8
    v_sub_f32 v9, v128, v10
    v_sub_f32 v8, v129, v10
    v_fmac_f32 v11, v9, v9
    v_fmac_f32 v12, v8, v8
    v_sub_f32 v9, v130, v10
    v_sub_f32 v8, v131, v10
    v_fmac_f32 v11, v9, v9
    v_fmac_f32 v12, v8, v8
    v_sub_f32 v9, v132, v10
    v_sub_f32 v8, v133, v10
    v_fmac_f32 v11, v9, v9
    v_fmac_f32 v12, v8, v8
    v_sub_f32 v9, v134, v10
    v_sub_f32 v8, v135, v10
    v_fmac_f32 v11, v9, v9
    v_fmac_f32 v12, v8, v8
    v_sub_f32 v9, v136, v10
    v_sub_f32 v8, v137, v10
    v_fmac_f32 v11, v9, v9
    v_fmac_f32 v12, v8, v8
    v_sub_f32 v9, v138, v10
    v_sub_f32 v8, v139, v10
    v_fmac_f32 v11, v9, v9
    v_fmac_f32 v12, v8, v8
    v_sub_f32 v9, v140, v10
    v_sub_f32 v8, v141, v10
    v_fmac_f32 v11, v9, v9
    v_fmac_f32 v12, v8, v8
    v_sub_f32 v9, v142, v10
    v_sub_f32 v8, v143, v10
    v_fmac_f32 v11, v9, v9
    v_fmac_f32 v12, v8, v8
    v_add_f32 v11, v11, v12
    s_nop 1
    v_add_f32_dpp v11, v11, v11 quad_perm:[1,0,3,2] row_mask:0xf bank_mask:0xf
    s_nop 1
    v_add_f32_dpp v11, v11, v11 quad_perm:[2,3,0,1] row_mask:0xf bank_mask:0xf
    s_nop 1
    v_add_f32_dpp v11, v11, v11 row_half_mirror row_mask:0xf bank_mask:0xf
    s_nop 1
    v_add_f32_dpp v11, v11, v11 row_mirror row_mask:0xf bank_mask:0xf
    v_mov_b32 v9, v11
    s_nop 1
    v_permlane16_swap_b32 v11, v9
    s_nop 1
    v_add_f32 v11, v11, v9
    v_mul_f32 v11, 0x3ae38e39, v11
    v_cvt_pk_bf16_f32 v10, v10, v10
    v_and_b32 v10, 0xffff0000, v10
    v_cvt_pk_bf16_f32 v11, v11, v11
    v_and_b32 v11, 0xffff0000, v11
    v_add_f32 v11, 0x3727c5ac, v11
    v_cvt_pk_bf16_f32 v11, v11, v11
    v_and_b32 v11, 0xffff0000, v11
    v_sqrt_f32 v12, v11
    s_nop 0
    v_cvt_pk_bf16_f32 v12, v12, v12
    v_and_b32 v12, 0xffff0000, v12
    v_rcp_f32 v13, v12
    v_and_b32 v8, 31, v0
    v_lshlrev_b32 v8, 2, v8
    v_lshrrev_b32 v9, 5, v0
    v_mul_u32_u24 v9, 1152, v9
    v_add_u32 v8, v8, v9
    v_sub_f32 v126, v126, v10
    v_sub_f32 v127, v127, v10
    v_sub_f32 v128, v128, v10
    v_sub_f32 v129, v129, v10
    v_sub_f32 v130, v130, v10
    v_sub_f32 v131, v131, v10
    v_sub_f32 v132, v132, v10
    v_sub_f32 v133, v133, v10
    v_sub_f32 v134, v134, v10
    v_sub_f32 v135, v135, v10
    v_sub_f32 v136, v136, v10
    v_sub_f32 v137, v137, v10
    v_sub_f32 v138, v138, v10
    v_sub_f32 v139, v139, v10
    v_sub_f32 v140, v140, v10
    v_sub_f32 v141, v141, v10
    v_sub_f32 v142, v142, v10
    v_sub_f32 v143, v143, v10
    v_cvt_pk_bf16_f32 v116, v126, v127
    v_cvt_pk_bf16_f32 v117, v128, v129
    v_cvt_pk_bf16_f32 v118, v130, v131
    v_cvt_pk_bf16_f32 v119, v132, v133
    v_cvt_pk_bf16_f32 v120, v134, v135
    v_cvt_pk_bf16_f32 v121, v136, v137
    v_cvt_pk_bf16_f32 v122, v138, v139
    v_cvt_pk_bf16_f32 v123, v140, v141
    v_cvt_pk_bf16_f32 v124, v142, v143
    v_lshlrev_b32 v126, 16, v116
    v_and_b32 v127, 0xffff0000, v116
    v_mul_f32 v9, v126, v13
    v_mul_f32 v11, v127, v13
    v_fma_f32 v126, -v9, v12, v126
    v_fma_f32 v127, -v11, v12, v127
    v_fma_f32 v126, v126, v13, v9
    v_fma_f32 v127, v127, v13, v11
    v_cvt_pk_bf16_f32 v116, v126, v127
    ds_write_b32 v8, v116 offset:11520
    v_lshlrev_b32 v128, 16, v117
    v_and_b32 v129, 0xffff0000, v117
    v_mul_f32 v9, v128, v13
    v_mul_f32 v11, v129, v13
    v_fma_f32 v128, -v9, v12, v128
    v_fma_f32 v129, -v11, v12, v129
    v_fma_f32 v128, v128, v13, v9
    v_fma_f32 v129, v129, v13, v11
    v_cvt_pk_bf16_f32 v117, v128, v129
    ds_write_b32 v8, v117 offset:11648
    v_lshlrev_b32 v130, 16, v118
    v_and_b32 v131, 0xffff0000, v118
    v_mul_f32 v9, v130, v13
    v_mul_f32 v11, v131, v13
    v_fma_f32 v130, -v9, v12, v130
    v_fma_f32 v131, -v11, v12, v131
    v_fma_f32 v130, v130, v13, v9
    v_fma_f32 v131, v131, v13, v11
    v_cvt_pk_bf16_f32 v118, v130, v131
    ds_write_b32 v8, v118 offset:11776
    v_lshlrev_b32 v132, 16, v119
    v_and_b32 v133, 0xffff0000, v119
    v_mul_f32 v9, v132, v13
    v_mul_f32 v11, v133, v13
    v_fma_f32 v132, -v9, v12, v132
    v_fma_f32 v133, -v11, v12, v133
    v_fma_f32 v132, v132, v13, v9
    v_fma_f32 v133, v133, v13, v11
    v_cvt_pk_bf16_f32 v119, v132, v133
    ds_write_b32 v8, v119 offset:11904
    v_lshlrev_b32 v134, 16, v120
    v_and_b32 v135, 0xffff0000, v120
    v_mul_f32 v9, v134, v13
    v_mul_f32 v11, v135, v13
    v_fma_f32 v134, -v9, v12, v134
    v_fma_f32 v135, -v11, v12, v135
    v_fma_f32 v134, v134, v13, v9
    v_fma_f32 v135, v135, v13, v11
    v_cvt_pk_bf16_f32 v120, v134, v135
    ds_write_b32 v8, v120 offset:12032
    v_lshlrev_b32 v136, 16, v121
    v_and_b32 v137, 0xffff0000, v121
    v_mul_f32 v9, v136, v13
    v_mul_f32 v11, v137, v13
    v_fma_f32 v136, -v9, v12, v136
    v_fma_f32 v137, -v11, v12, v137
    v_fma_f32 v136, v136, v13, v9
    v_fma_f32 v137, v137, v13, v11
    v_cvt_pk_bf16_f32 v121, v136, v137
    ds_write_b32 v8, v121 offset:12160
    v_lshlrev_b32 v138, 16, v122
    v_and_b32 v139, 0xffff0000, v122
    v_mul_f32 v9, v138, v13
    v_mul_f32 v11, v139, v13
    v_fma_f32 v138, -v9, v12, v138
    v_fma_f32 v139, -v11, v12, v139
    v_fma_f32 v138, v138, v13, v9
    v_fma_f32 v139, v139, v13, v11
    v_cvt_pk_bf16_f32 v122, v138, v139
    ds_write_b32 v8, v122 offset:12288
    v_lshlrev_b32 v140, 16, v123
    v_and_b32 v141, 0xffff0000, v123
    v_mul_f32 v9, v140, v13
    v_mul_f32 v11, v141, v13
    v_fma_f32 v140, -v9, v12, v140
    v_fma_f32 v141, -v11, v12, v141
    v_fma_f32 v140, v140, v13, v9
    v_fma_f32 v141, v141, v13, v11
    v_cvt_pk_bf16_f32 v123, v140, v141
    ds_write_b32 v8, v123 offset:12416
    v_lshlrev_b32 v142, 16, v124
    v_and_b32 v143, 0xffff0000, v124
    v_mul_f32 v9, v142, v13
    v_mul_f32 v11, v143, v13
    v_fma_f32 v142, -v9, v12, v142
    v_fma_f32 v143, -v11, v12, v143
    v_fma_f32 v142, v142, v13, v9
    v_fma_f32 v143, v143, v13, v11
    v_cvt_pk_bf16_f32 v124, v142, v143
    ds_write_b32 v8, v124 offset:12544
    v_mov_b32 v6, 16
    v_mov_b32 v7, 0
    ds_write_b64 v148, v[6:7]
    s_waitcnt vmcnt(0) lgkmcnt(0)
L_A0:
    v_add_u32 v6, 8, v153
    v_add_u32 v7, 16, v153
    v_min_u32 v7, 575, v7
    v_lshlrev_b32 v153, 1, v153
    v_lshlrev_b32 v6, 1, v6
    v_lshlrev_b32 v7, 1, v7
    s_barrier
    ds_read_u16 v8, v153 offset:11520
    ds_read_u16 v9, v153 offset:12672
    ds_read_u16 v10, v6 offset:11520
    ds_read_u16 v11, v6 offset:12672
    ds_read_u16 v12, v7 offset:11520
    ds_read_u16 v13, v7 offset:12672
    s_waitcnt lgkmcnt(0)
    s_add_u32 s90, s90, 0x9e3779b9
    v_lshlrev_b32 v8, 16, v8
    v_lshlrev_b32 v9, 16, v9
    v_lshlrev_b32 v10, 16, v10
    v_lshlrev_b32 v11, 16, v11
    v_lshlrev_b32 v12, 16, v12
    v_lshlrev_b32 v13, 16, v13
    s_waitcnt vmcnt(8)
    v_lshlrev_b32 v14, 16, v36
    v_and_b32 v15, 0xffff0000, v36
    v_mul_f32 v16, v14, v8
    v_mul_f32 v17, v15, v8
    v_mul_f32 v24, v14, v9
    v_mul_f32 v25, v15, v9
    v_lshlrev_b32 v14, 16, v37
    v_and_b32 v15, 0xffff0000, v37
    v_mul_f32 v18, v14, v8
    v_mul_f32 v19, v15, v8
    v_mul_f32 v26, v14, v9
    v_mul_f32 v27, v15, v9
    v_lshlrev_b32 v14, 16, v38
    v_and_b32 v15, 0xffff0000, v38
    v_mul_f32 v20, v14, v8
    v_mul_f32 v21, v15, v8
    v_mul_f32 v28, v14, v9
    v_mul_f32 v29, v15, v9
    v_lshlrev_b32 v14, 16, v39
    v_and_b32 v15, 0xffff0000, v39
    v_mul_f32 v22, v14, v8
    v_mul_f32 v23, v15, v8
    v_mul_f32 v30, v14, v9
    v_mul_f32 v31, v15, v9
    v_lshlrev_b32 v14, 16, v40
    v_and_b32 v15, 0xffff0000, v40
    v_fmac_f32 v16, v14, v10
    v_fmac_f32 v17, v15, v10
    v_fmac_f32 v24, v14, v11
    v_fmac_f32 v25, v15, v11
    v_lshlrev_b32 v14, 16, v41
    v_and_b32 v15, 0xffff0000, v41
    v_fmac_f32 v18, v14, v10
    v_fmac_f32 v19, v15, v10
    v_fmac_f32 v26, v14, v11
    v_fmac_f32 v27, v15, v11
    v_lshlrev_b32 v14, 16, v42
    v_and_b32 v15, 0xffff0000, v42
    v_fmac_f32 v20, v14, v10
    v_fmac_f32 v21, v15, v10
    v_fmac_f32 v28, v14, v11
    v_fmac_f32 v29, v15, v11
    v_lshlrev_b32 v14, 16, v43
    v_and_b32 v15, 0xffff0000, v43
    v_fmac_f32 v22, v14, v10
    v_fmac_f32 v23, v15, v10
    v_fmac_f32 v30, v14, v11
    v_fmac_f32 v31, v15, v11
    v_lshlrev_b32 v14, 16, v44
    v_and_b32 v15, 0xffff0000, v44
    v_fmac_f32 v16, v14, v12
    v_fmac_f32 v17, v15, v12
    v_fmac_f32 v24, v14, v13
    v_fmac_f32 v25, v15, v13
    v_lshlrev_b32 v14, 16, v45
    v_and_b32 v15, 0xffff0000, v45
    v_fmac_f32 v18, v14, v12
    v_fmac_f32 v19, v15, v12
    v_fmac_f32 v26, v14, v13
    v_fmac_f32 v27, v15, v13
    v_lshlrev_b32 v14, 16, v46
    v_and_b32 v15, 0xffff0000, v46
    v_fmac_f32 v20, v14, v12
    v_fmac_f32 v21, v15, v12
    v_fmac_f32 v28, v14, v13
    v_fmac_f32 v29, v15, v13
    v_lshlrev_b32 v14, 16, v47
    v_and_b32 v15, 0xffff0000, v47
    v_fmac_f32 v22, v14, v12
    v_fmac_f32 v23, v15, v12
    v_fmac_f32 v30, v14, v13
    v_fmac_f32 v31, v15, v13
    s_nop 1
    v_permlane32_swap_b32 v16, v24
    v_permlane32_swap_b32 v17, v25
    v_permlane32_swap_b32 v18, v26
    v_permlane32_swap_b32 v19, v27
    v_permlane32_swap_b32 v20, v28
    v_permlane32_swap_b32 v21, v29
    v_permlane32_swap_b32 v22, v30
    v_permlane32_swap_b32 v23, v31
    s_nop 1
    v_add_f32 v16, v16, v24
    v_add_f32 v17, v17, v25
    v_add_f32 v18, v18, v26
    v_add_f32 v19, v19, v27
    v_add_f32 v20, v20, v28
    v_add_f32 v21, v21, v29
    v_add_f32 v22, v22, v30
    v_add_f32 v23, v23, v31
    s_nop 1
    v_permlane16_swap_b32 v16, v20
    v_permlane16_swap_b32 v17, v21
    v_permlane16_swap_b32 v18, v22
    v_permlane16_swap_b32 v19, v23
    s_nop 1
    v_add_f32 v16, v16, v20
    v_add_f32 v17, v17, v21
    v_add_f32 v18, v18, v22
    v_add_f32 v19, v19, v23
    s_nop 1
    v_add_f32_dpp v16, v16, v16 row_ror:8 row_mask:0xf bank_mask:0xf
    v_add_f32_dpp v17, v17, v17 row_ror:8 row_mask:0xf bank_mask:0xf
    v_add_f32_dpp v18, v18, v18 row_ror:8 row_mask:0xf bank_mask:0xf
    v_add_f32_dpp v19, v19, v19 row_ror:8 row_mask:0xf bank_mask:0xf
    v_lshrrev_b32 v6, 5, v0
    v_lshlrev_b32 v6, 8, v6
    v_and_b32 v7, 7, v0
    v_lshl_add_u32 v6, v7, 5, v6
    v_bfe_u32 v7, v0, 4, 1
    v_lshl_add_u32 v6, v7, 4, v6
    s_lshl_b32 s72, s3, 9
    v_add_u32 v6, s72, v6
    ds_write_b128 v6, v[16:19] offset:7424
    s_waitcnt lgkmcnt(0)
    s_barrier
    s_cmp_eq_u32 s3, 0
    s_cbranch_scc0 L_prefetch
    v_lshlrev_b32 v6, 3, v0
    ds_read_b64 v[16:17], v6 offset:7424
    ds_read_b64 v[18:19], v6 offset:7936
    ds_read_b64 v[20:21], v6 offset:8448
    ds_read_b64 v[22:23], v6 offset:8960
    ds_read_b64 v[24:25], v6 offset:9472
    ds_read_b64 v[26:27], v6 offset:9984
    ds_read_b64 v[28:29], v6 offset:10496
    ds_read_b64 v[30:31], v6 offset:11008
    v_lshrrev_b32 v6, 5, v0
    v_lshlrev_b32 v6, 15, v6
    v_and_b32 v7, 31, v0
    v_lshl_add_u32 v6, v7, 4, v6
    s_lshl_b32 s72, s74, 16
    s_lshl_b32 s91, s73, 9
    s_add_u32 s72, s72, s91
    s_add_u32 s72, s72, 65536
    v_mov_b32 v9, s90
    v_mov_b32 v11, s90
    s_waitcnt lgkmcnt(0)
    v_add_f32 v8, v16, v18
    v_add_f32 v10, v17, v19
    v_add_f32 v8, v8, v20
    v_add_f32 v10, v10, v21
    v_add_f32 v8, v8, v22
    v_add_f32 v10, v10, v23
    v_add_f32 v8, v8, v24
    v_add_f32 v10, v10, v25
    v_add_f32 v8, v8, v26
    v_add_f32 v10, v10, v27
    v_add_f32 v8, v8, v28
    v_add_f32 v10, v10, v29
    v_add_f32 v8, v8, v30
    v_add_f32 v10, v10, v31
    buffer_store_dwordx4 v[8:11], v6, s[64:67], s72 offen sc1
    s_lshr_b32 s72, s84, 4
    s_lshl_b32 s72, s72, 15
    s_and_b32 s91, s84, 15
    s_lshl_b32 s91, s91, 11
    s_add_u32 s72, s72, s91
    s_add_u32 s76, s72, 65536
    s_add_u32 s77, s76, 65536
    s_add_u32 s78, s76, 131072
    s_add_u32 s79, s76, 196608
    v_and_b32 v6, 3, v0
    v_lshlrev_b32 v6, 16, v6
    v_bfe_u32 v7, v0, 2, 2
    v_lshl_add_u32 v6, v7, 9, v6
    s_mov_b32 s91, 1048576
    buffer_load_dwordx2 v[12:13], v6, s[64:67], s76 offen sc1
L_pollq0:
    s_waitcnt vmcnt(0)
    v_cmp_ne_u32 s[92:93], s90, v13
    s_nop 3
    s_cmp_eq_u64 s[92:93], 0
    s_cbranch_scc1 L_pollq0_ok0
    s_sub_u32 s91, s91, 1
    s_cbranch_scc1 L_pollq0_ok0
    s_sleep 4
    buffer_load_dwordx2 v[12:13], v6, s[64:67], s76 offen sc1
    s_branch L_pollq0
L_pollq0_ok0:
L_pollq0_done:
    s_mov_b32 s91, 1048576
    buffer_load_dwordx4 v[16:19], v2, s[64:67], s76 offen offset:0 sc1
    buffer_load_dwordx4 v[20:23], v2, s[64:67], s76 offen offset:1024 sc1
    buffer_load_dwordx4 v[24:27], v2, s[64:67], s77 offen offset:0 sc1
    buffer_load_dwordx4 v[28:31], v2, s[64:67], s77 offen offset:1024 sc1
    buffer_load_dwordx4 v[32:35], v2, s[64:67], s78 offen offset:0 sc1
    buffer_load_dwordx4 v[36:39], v2, s[64:67], s78 offen offset:1024 sc1
    buffer_load_dwordx4 v[40:43], v2, s[64:67], s79 offen offset:0 sc1
    buffer_load_dwordx4 v[44:47], v2, s[64:67], s79 offen offset:1024 sc1
L_pollq:
    s_waitcnt vmcnt(0)
    v_xor_b32 v9, s90, v17
    v_xor_b32 v10, s90, v19
    v_xor_b32 v11, s90, v21
    v_or3_b32 v9, v9, v10, v11
    v_xor_b32 v10, s90, v23
    v_xor_b32 v11, s90, v25
    v_or3_b32 v9, v9, v10, v11
    v_xor_b32 v10, s90, v27
    v_xor_b32 v11, s90, v29
    v_or3_b32 v9, v9, v10, v11
    v_xor_b32 v10, s90, v31
    v_xor_b32 v11, s90, v33
    v_or3_b32 v9, v9, v10, v11
    v_xor_b32 v10, s90, v35
    v_xor_b32 v11, s90, v37
    v_or3_b32 v9, v9, v10, v11
    v_xor_b32 v10, s90, v39
    v_xor_b32 v11, s90, v41
    v_or3_b32 v9, v9, v10, v11
    v_xor_b32 v10, s90, v43
    v_xor_b32 v11, s90, v45
    v_or3_b32 v9, v9, v10, v11
    v_xor_b32 v10, s90, v47
    v_or_b32 v9, v9, v10
    v_cmp_ne_u32 s[92:93], 0, v9
    s_nop 3
    s_cmp_eq_u64 s[92:93], 0
    s_cbranch_scc1 L_pollq_ok0
    s_sub_u32 s91, s91, 1
    s_cbranch_scc1 L_pollq_ok0
    s_sleep 4
    buffer_load_dwordx4 v[16:19], v2, s[64:67], s76 offen offset:0 sc1
    buffer_load_dwordx4 v[20:23], v2, s[64:67], s76 offen offset:1024 sc1
    buffer_load_dwordx4 v[24:27], v2, s[64:67], s77 offen offset:0 sc1
    buffer_load_dwordx4 v[28:31], v2, s[64:67], s77 offen offset:1024 sc1
    buffer_load_dwordx4 v[32:35], v2, s[64:67], s78 offen offset:0 sc1
    buffer_load_dwordx4 v[36:39], v2, s[64:67], s78 offen offset:1024 sc1
    buffer_load_dwordx4 v[40:43], v2, s[64:67], s79 offen offset:0 sc1
    buffer_load_dwordx4 v[44:47], v2, s[64:67], s79 offen offset:1024 sc1
    s_branch L_pollq
L_pollq_ok0:
L_pollq_done:
    v_add_f32 v16, v16, v24
    v_add_f32 v32, v32, v40
    v_add_f32 v16, v16, v32
    v_add_f32 v18, v18, v26
    v_add_f32 v34, v34, v42
    v_add_f32 v18, v18, v34
    v_cvt_pk_bf16_f32 v8, v16, v18
    v_add_f32 v20, v20, v28
    v_add_f32 v36, v36, v44
    v_add_f32 v20, v20, v36
    v_add_f32 v22, v22, v30
    v_add_f32 v38, v38, v46
    v_add_f32 v22, v22, v38
    v_cvt_pk_bf16_f32 v9, v20, v22
    v_lshlrev_b32 v6, 2, v0
    ds_write_b32 v6, v8 offset:6144
    ds_write_b32 v6, v9 offset:6400
    s_waitcnt lgkmcnt(0)
    s_branch L_B
L_prefetch:
    s_mul_i32 s74, s69, 171
    s_lshr_b32 s74, s74, 9
    s_mul_i32 s72, s74, 3
    s_sub_u32 s75, s69, s72
    s_cmp_lt_u32 s69, 216
    s_cselect_b32 s79, 1, 0
    s_cmp_lt_u32 s3, 7
    s_cselect_b32 s79, s79, 0
    s_cmp_eq_u32 s79, 0
    s_cbranch_scc1 L_nogu1
    s_mul_i32 s76, s75, 192
    s_lshl_b32 s72, s3, 5
    s_add_u32 s76, s76, s72
    s_sub_u32 s76, s76, 32
    v_lshl_add_u32 v6, v150, 3, s76
    v_mul_u32_u24 v7, 9216, v6
    v_lshl_add_u32 v7, v151, 4, v7
    s_lshr_b32 s77, s74, 1
    s_lshl_b32 s77, s77, 8
    v_and_b32 v8, 1, v0
    v_mul_u32_u24 v8, 1152, v8
    v_lshl_add_u32 v8, v6, 1, v8
    ds_read_b128 v[12:15], v8 offset:11520
    s_waitcnt vmcnt(4)
    s_bitcmp1_b32 s74, 0
    s_cbranch_scc1 L_gu_up
    buffer_load_dwordx4 v[52:55], v7, s[48:51], s77 offen nt
    s_add_u32 s77, s77, 9216
    buffer_load_dwordx4 v[56:59], v7, s[48:51], s77 offen nt
    s_add_u32 s77, s77, 9216
    buffer_load_dwordx4 v[60:63], v7, s[48:51], s77 offen nt
    s_add_u32 s77, s77, 9216
    buffer_load_dwordx4 v[64:67], v7, s[48:51], s77 offen nt
    s_add_u32 s77, s77, 9216
    buffer_load_dwordx4 v[68:71], v7, s[48:51], s77 offen nt
    s_add_u32 s77, s77, 9216
    buffer_load_dwordx4 v[72:75], v7, s[48:51], s77 offen nt
    s_add_u32 s77, s77, 9216
    buffer_load_dwordx4 v[76:79], v7, s[48:51], s77 offen nt
    s_add_u32 s77, s77, 9216
    buffer_load_dwordx4 v[80:83], v7, s[48:51], s77 offen nt
    s_branch L_nogu1
L_gu_up:
    buffer_load_dwordx4 v[52:55], v7, s[52:55], s77 offen nt
    s_add_u32 s77, s77, 9216
    buffer_load_dwordx4 v[56:59], v7, s[52:55], s77 offen nt
    s_add_u32 s77, s77, 9216
    buffer_load_dwordx4 v[60:63], v7, s[52:55], s77 offen nt
    s_add_u32 s77, s77, 9216
    buffer_load_dwordx4 v[64:67], v7, s[52:55], s77 offen nt
    s_add_u32 s77, s77, 9216
    buffer_load_dwordx4 v[68:71], v7, s[52:55], s77 offen nt
    s_add_u32 s77, s77, 9216
    buffer_load_dwordx4 v[72:75], v7, s[52:55], s77 offen nt
    s_add_u32 s77, s77, 9216
    buffer_load_dwordx4 v[76:79], v7, s[52:55], s77 offen nt
    s_add_u32 s77, s77, 9216
    buffer_load_dwordx4 v[80:83], v7, s[52:55], s77 offen nt
L_nogu1:
    s_waitcnt vmcnt(4)
    buffer_load_dwordx4 v[84:87], v2, s[36:39], s94 offen offset:0 nt
    buffer_load_dwordx4 v[88:91], v2, s[36:39], s94 offen offset:1024 nt
    buffer_load_dwordx4 v[92:95], v2, s[36:39], s94 offen offset:2048 nt
    buffer_load_dwordx4 v[96:99], v2, s[36:39], s94 offen offset:3072 nt
    buffer_load_dwordx4 v[100:103], v2, s[36:39], s95 offen offset:0 nt
    buffer_load_dwordx4 v[104:107], v2, s[36:39], s95 offen offset:1024 nt
    buffer_load_dwordx4 v[108:111], v2, s[36:39], s95 offen offset:2048 nt
    buffer_load_dwordx4 v[112:115], v2, s[36:39], s95 offen offset:3072 nt
    s_cmp_eq_u32 s79, 0
    s_cbranch_scc1 L_nogu2
    v_and_b32 v6, 2, v151
    v_cmp_ne_u32 s[4:5], 0, v6
    v_and_b32 v6, 4, v151
    v_cmp_ne_u32 s[6:7], 0, v6
    v_and_b32 v6, 8, v151
    v_cmp_ne_u32 s[8:9], 0, v6
    s_waitcnt vmcnt(8) lgkmcnt(0)
    v_perm_b32 v48, v56, v52, s82
    v_perm_b32 v49, v64, v60, s82
    v_perm_b32 v50, v72, v68, s82
    v_perm_b32 v51, v80, v76, s82
    s_nop 1
    v_mfma_f32_16x16x32_bf16 v[16:19], v[48:51], v[12:15], 0
    v_perm_b32 v8, v56, v52, s83
    v_perm_b32 v9, v64, v60, s83
    v_perm_b32 v10, v72, v68, s83
    v_perm_b32 v11, v80, v76, s83
    s_nop 1
    v_mfma_f32_16x16x32_bf16 v[20:23], v[8:11], v[12:15], 0
    v_perm_b32 v48, v57, v53, s82
    v_perm_b32 v49, v65, v61, s82
    v_perm_b32 v50, v73, v69, s82
    v_perm_b32 v51, v81, v77, s82
    s_nop 1
    v_mfma_f32_16x16x32_bf16 v[24:27], v[48:51], v[12:15], 0
    v_perm_b32 v8, v57, v53, s83
    v_perm_b32 v9, v65, v61, s83
    v_perm_b32 v10, v73, v69, s83
    v_perm_b32 v11, v81, v77, s83
    s_nop 1
    v_mfma_f32_16x16x32_bf16 v[28:31], v[8:11], v[12:15], 0
    v_perm_b32 v48, v58, v54, s82
    v_perm_b32 v49, v66, v62, s82
    v_perm_b32 v50, v74, v70, s82
    v_perm_b32 v51, v82, v78, s82
    s_nop 1
    v_mfma_f32_16x16x32_bf16 v[32:35], v[48:51], v[12:15], 0
    v_perm_b32 v8, v58, v54, s83
    v_perm_b32 v9, v66, v62, s83
    v_perm_b32 v10, v74, v70, s83
    v_perm_b32 v11, v82, v78, s83
    s_nop 1
    v_mfma_f32_16x16x32_bf16 v[36:39], v[8:11], v[12:15], 0
    v_perm_b32 v48, v59, v55, s82
    v_perm_b32 v49, v67, v63, s82
    v_perm_b32 v50, v75, v71, s82
    v_perm_b32 v51, v83, v79, s82
    s_nop 1
    v_mfma_f32_16x16x32_bf16 v[40:43], v[48:51], v[12:15], 0
    v_perm_b32 v8, v59, v55, s83
    v_perm_b32 v9, v67, v63, s83
    v_perm_b32 v10, v75, v71, s83
    v_perm_b32 v11, v83, v79, s83
    s_nop 1
    v_mfma_f32_16x16x32_bf16 v[44:47], v[8:11], v[12:15], 0
    s_lshl_b32 s72, s3, 10
    s_sub_u32 s72, s72, 1024
    v_add_u32 v6, s72, v2
    s_nop 7
    v_cndmask_b32 v16, v16, v20, s[4:5]
    v_cndmask_b32 v17, v17, v21, s[4:5]
    v_cndmask_b32 v18, v18, v22, s[4:5]
    v_cndmask_b32 v19, v19, v23, s[4:5]
    v_cndmask_b32 v24, v24, v28, s[4:5]
    v_cndmask_b32 v25, v25, v29, s[4:5]
    v_cndmask_b32 v26, v26, v30, s[4:5]
    v_cndmask_b32 v27, v27, v31, s[4:5]
    v_cndmask_b32 v32, v32, v36, s[4:5]
    v_cndmask_b32 v33, v33, v37, s[4:5]
    v_cndmask_b32 v34, v34, v38, s[4:5]
    v_cndmask_b32 v35, v35, v39, s[4:5]
    v_cndmask_b32 v40, v40, v44, s[4:5]
    v_cndmask_b32 v41, v41, v45, s[4:5]
    v_cndmask_b32 v42, v42, v46, s[4:5]
    v_cndmask_b32 v43, v43, v47, s[4:5]
    v_cndmask_b32 v16, v16, v24, s[6:7]
    v_cndmask_b32 v17, v17, v25, s[6:7]
    v_cndmask_b32 v18, v18, v26, s[6:7]
    v_cndmask_b32 v19, v19, v27, s[6:7]
    v_cndmask_b32 v32, v32, v40, s[6:7]
    v_cndmask_b32 v33, v33, v41, s[6:7]
    v_cndmask_b32 v34, v34, v42, s[6:7]
    v_cndmask_b32 v35, v35, v43, s[6:7]
    v_cndmask_b32 v8, v16, v32, s[8:9]
    v_cndmask_b32 v9, v17, v33, s[8:9]
    v_cndmask_b32 v10, v18, v34, s[8:9]
    v_cndmask_b32 v11, v19, v35, s[8:9]
    ds_write_b128 v6, v[8:11] offset:0
L_nogu2:
    s_waitcnt vmcnt(4)
    s_add_u32 s72, s99, s85
    s_and_b32 s72, s72, 1023
    s_lshl_b32 s72, s72, 13
    s_add_u32 s72, s72, s88
    s_cmp_lt_u32 s99, 1024
    s_cselect_b32 s96, s72, 1073741824
    s_add_u32 s97, s96, 4096
    buffer_load_dwordx4 a[32:35], v1, s[32:35], s96 offen offset:0 nt
    buffer_load_dwordx4 a[36:39], v1, s[32:35], s96 offen offset:64 nt
    buffer_load_dwordx4 a[40:43], v1, s[32:35], s96 offen offset:128 nt
    buffer_load_dwordx4 a[44:47], v1, s[32:35], s96 offen offset:192 nt
    buffer_load_dwordx4 a[48:51], v1, s[32:35], s97 offen offset:0 nt
    buffer_load_dwordx4 a[52:55], v1, s[32:35], s97 offen offset:64 nt
    buffer_load_dwordx4 a[56:59], v1, s[32:35], s97 offen offset:128 nt
    buffer_load_dwordx4 a[60:63], v1, s[32:35], s97 offen offset:192 nt
    s_waitcnt vmcnt(4)
    buffer_load_dwordx4 v[116:119], v2, s[36:39], s96 offen offset:0 nt
    buffer_load_dwordx4 v[120:123], v2, s[36:39], s96 offen offset:1024 nt
    buffer_load_dwordx4 v[124:127], v2, s[36:39], s96 offen offset:2048 nt
    buffer_load_dwordx4 v[128:131], v2, s[36:39], s96 offen offset:3072 nt
    buffer_load_dwordx4 v[132:135], v2, s[36:39], s97 offen offset:0 nt
    buffer_load_dwordx4 v[136:139], v2, s[36:39], s97 offen offset:1024 nt
    buffer_load_dwordx4 v[140:143], v2, s[36:39], s97 offen offset:2048 nt
    buffer_load_dwordx4 v[144:147], v2, s[36:39], s97 offen offset:3072 nt
    s_cmp_lt_u32 s68, 100
    s_cbranch_scc0 L_nodma_2
    s_cmp_lt_u32 s68, 64
    s_cbranch_scc0 L_dma_wd_1
    s_mul_i32 s91, s68, 73728
    s_mul_i32 s72, s3, 9216
    s_add_u32 s91, s91, s72
    s_waitcnt vmcnt(4)
    s_add_u32 m0, s72, 16384
    s_add_u32 s78, s91, 0
    buffer_load_dwordx4 v2, s[44:47], s78 offen offset:0 nt lds
    buffer_load_dwordx4 v2, s[44:47], s78 offen offset:1024 nt lds
    buffer_load_dwordx4 v2, s[44:47], s78 offen offset:2048 nt lds
    buffer_load_dwordx4 v2, s[44:47], s78 offen offset:3072 nt lds
    s_add_u32 m0, s72, 20480
    s_add_u32 s78, s91, 4096
    buffer_load_dwordx4 v2, s[44:47], s78 offen offset:0 nt lds
    buffer_load_dwordx4 v2, s[44:47], s78 offen offset:1024 nt lds
    buffer_load_dwordx4 v2, s[44:47], s78 offen offset:2048 nt lds
    buffer_load_dwordx4 v2, s[44:47], s78 offen offset:3072 nt lds
    s_waitcnt vmcnt(4)
    s_add_u32 m0, s72, 24576
    s_add_u32 s78, s91, 8192
    buffer_load_dwordx4 v2, s[44:47], s78 offen offset:0 nt lds
    s_branch L_nodma_2
L_dma_wd_1:
    s_sub_u32 s91, s68, 64
    s_mul_i32 s91, s91, 147456
    s_mul_i32 s72, s3, 18432
    s_add_u32 s91, s91, s72
    s_waitcnt vmcnt(4)
    s_add_u32 m0, s72, 16384
    s_add_u32 s78, s91, 0
    buffer_load_dwordx4 v2, s[56:59], s78 offen offset:0 nt lds
    buffer_load_dwordx4 v2, s[56:59], s78 offen offset:1024 nt lds
    buffer_load_dwordx4 v2, s[56:59], s78 offen offset:2048 nt lds
    buffer_load_dwordx4 v2, s[56:59], s78 offen offset:3072 nt lds
    s_add_u32 m0, s72, 20480
    s_add_u32 s78, s91, 4096
    buffer_load_dwordx4 v2, s[56:59], s78 offen offset:0 nt lds
    buffer_load_dwordx4 v2, s[56:59], s78 offen offset:1024 nt lds
    buffer_load_dwordx4 v2, s[56:59], s78 offen offset:2048 nt lds
    buffer_load_dwordx4 v2, s[56:59], s78 offen offset:3072 nt lds
    s_waitcnt vmcnt(4)
    s_add_u32 m0, s72, 24576
    s_add_u32 s78, s91, 8192
    buffer_load_dwordx4 v2, s[56:59], s78 offen offset:0 nt lds
    buffer_load_dwordx4 v2, s[56:59], s78 offen offset:1024 nt lds
    buffer_load_dwordx4 v2, s[56:59], s78 offen offset:2048 nt lds
    buffer_load_dwordx4 v2, s[56:59], s78 offen offset:3072 nt lds
    s_add_u32 m0, s72, 28672
    s_add_u32 s78, s91, 12288
    buffer_load_dwordx4 v2, s[56:59], s78 offen offset:0 nt lds
    buffer_load_dwordx4 v2, s[56:59], s78 offen offset:1024 nt lds
    buffer_load_dwordx4 v2, s[56:59], s78 offen offset:2048 nt lds
    buffer_load_dwordx4 v2, s[56:59], s78 offen offset:3072 nt lds
    s_waitcnt vmcnt(4)
    s_add_u32 m0, s72, 32768
    s_add_u32 s78, s91, 16384
    buffer_load_dwordx4 v2, s[56:59], s78 offen offset:0 nt lds
    buffer_load_dwordx4 v2, s[56:59], s78 offen offset:1024 nt lds
L_nodma_2:
    s_waitcnt lgkmcnt(0)
L_B:
    s_barrier
    v_and_b32 v6, 1, v0
    v_lshlrev_b32 v6, 8, v6
    v_lshl_add_u32 v6, v150, 4, v6
    ds_read_b128 v[36:39], v6 offset:6144
    ds_read_b128 v[40:43], v6 offset:6208
    ds_read_b128 v[44:47], v6 offset:6272
    ds_read_b128 v[48:51], v6 offset:6336
    s_cmp_eq_u32 s3, 0
    s_cbranch_scc0 L_w0_done
    s_add_u32 s98, s89, 14
    s_add_u32 s99, s89, 15
    s_add_u32 s72, s98, s85
    s_and_b32 s72, s72, 1023
    s_lshl_b32 s72, s72, 13
    s_add_u32 s72, s72, s88
    s_cmp_lt_u32 s98, 1024
    s_cselect_b32 s94, s72, 1073741824
    s_add_u32 s95, s94, 4096
    buffer_load_dwordx4 a[0:3], v1, s[32:35], s94 offen offset:0 nt
    buffer_load_dwordx4 a[4:7], v1, s[32:35], s94 offen offset:64 nt
    buffer_load_dwordx4 a[8:11], v1, s[32:35], s94 offen offset:128 nt
    buffer_load_dwordx4 a[12:15], v1, s[32:35], s94 offen offset:192 nt
    buffer_load_dwordx4 a[16:19], v1, s[32:35], s95 offen offset:0 nt
    buffer_load_dwordx4 a[20:23], v1, s[32:35], s95 offen offset:64 nt
    buffer_load_dwordx4 a[24:27], v1, s[32:35], s95 offen offset:128 nt
    buffer_load_dwordx4 a[28:31], v1, s[32:35], s95 offen offset:192 nt
    buffer_load_dwordx4 v[84:87], v2, s[36:39], s94 offen offset:0 nt
    buffer_load_dwordx4 v[88:91], v2, s[36:39], s94 offen offset:1024 nt
    buffer_load_dwordx4 v[92:95], v2, s[36:39], s94 offen offset:2048 nt
    buffer_load_dwordx4 v[96:99], v2, s[36:39], s94 offen offset:3072 nt
    buffer_load_dwordx4 v[100:103], v2, s[36:39], s95 offen offset:0 nt
    buffer_load_dwordx4 v[104:107], v2, s[36:39], s95 offen offset:1024 nt
    buffer_load_dwordx4 v[108:111], v2, s[36:39], s95 offen offset:2048 nt
    buffer_load_dwordx4 v[112:115], v2, s[36:39], s95 offen offset:3072 nt
    s_add_u32 s72, s99, s85
    s_and_b32 s72, s72, 1023
    s_lshl_b32 s72, s72, 13
    s_add_u32 s72, s72, s88
    s_cmp_lt_u32 s99, 1024
    s_cselect_b32 s96, s72, 1073741824
    s_add_u32 s97, s96, 4096
    buffer_load_dwordx4 a[32:35], v1, s[32:35], s96 offen offset:0 nt
    buffer_load_dwordx4 a[36:39], v1, s[32:35], s96 offen offset:64 nt
    buffer_load_dwordx4 a[40:43], v1, s[32:35], s96 offen offset:128 nt
    buffer_load_dwordx4 a[44:47], v1, s[32:35], s96 offen offset:192 nt
    buffer_load_dwordx4 a[48:51], v1, s[32:35], s97 offen offset:0 nt
    buffer_load_dwordx4 a[52:55], v1, s[32:35], s97 offen offset:64 nt
    buffer_load_dwordx4 a[56:59], v1, s[32:35], s97 offen offset:128 nt
    buffer_load_dwordx4 a[60:63], v1, s[32:35], s97 offen offset:192 nt
    buffer_load_dwordx4 v[116:119], v2, s[36:39], s96 offen offset:0 nt
    buffer_load_dwordx4 v[120:123], v2, s[36:39], s96 offen offset:1024 nt
    buffer_load_dwordx4 v[124:127], v2, s[36:39], s96 offen offset:2048 nt
    buffer_load_dwordx4 v[128:131], v2, s[36:39], s96 offen offset:3072 nt
    buffer_load_dwordx4 v[132:135], v2, s[36:39], s97 offen offset:0 nt
    buffer_load_dwordx4 v[136:139], v2, s[36:39], s97 offen offset:1024 nt
    buffer_load_dwordx4 v[140:143], v2, s[36:39], s97 offen offset:2048 nt
    buffer_load_dwordx4 v[144:147], v2, s[36:39], s97 offen offset:3072 nt
    s_cmp_lt_u32 s68, 100
    s_cbranch_scc0 L_nodma_4
    s_cmp_lt_u32 s68, 64
    s_cbranch_scc0 L_dma_wd_3
    s_mul_i32 s91, s68, 73728
    s_mul_i32 s72, s3, 9216
    s_add_u32 s91, s91, s72
    s_add_u32 m0, s72, 16384
    s_add_u32 s78, s91, 0
    buffer_load_dwordx4 v2, s[44:47], s78 offen offset:0 nt lds
    buffer_load_dwordx4 v2, s[44:47], s78 offen offset:1024 nt lds
    buffer_load_dwordx4 v2, s[44:47], s78 offen offset:2048 nt lds
    buffer_load_dwordx4 v2, s[44:47], s78 offen offset:3072 nt lds
    s_add_u32 m0, s72, 20480
    s_add_u32 s78, s91, 4096
    buffer_load_dwordx4 v2, s[44:47], s78 offen offset:0 nt lds
    buffer_load_dwordx4 v2, s[44:47], s78 offen offset:1024 nt lds
    buffer_load_dwordx4 v2, s[44:47], s78 offen offset:2048 nt lds
    buffer_load_dwordx4 v2, s[44:47], s78 offen offset:3072 nt lds
    s_add_u32 m0, s72, 24576
    s_add_u32 s78, s91, 8192
    buffer_load_dwordx4 v2, s[44:47], s78 offen offset:0 nt lds
    s_branch L_nodma_4
L_dma_wd_3:
    s_sub_u32 s91, s68, 64
    s_mul_i32 s91, s91, 147456
    s_mul_i32 s72, s3, 18432
    s_add_u32 s91, s91, s72
    s_add_u32 m0, s72, 16384
    s_add_u32 s78, s91, 0
    buffer_load_dwordx4 v2, s[56:59], s78 offen offset:0 nt lds
    buffer_load_dwordx4 v2, s[56:59], s78 offen offset:1024 nt lds
    buffer_load_dwordx4 v2, s[56:59], s78 offen offset:2048 nt lds
    buffer_load_dwordx4 v2, s[56:59], s78 offen offset:3072 nt lds
    s_add_u32 m0, s72, 20480
    s_add_u32 s78, s91, 4096
    buffer_load_dwordx4 v2, s[56:59], s78 offen offset:0 nt lds
    buffer_load_dwordx4 v2, s[56:59], s78 offen offset:1024 nt lds
    buffer_load_dwordx4 v2, s[56:59], s78 offen offset:2048 nt lds
    buffer_load_dwordx4 v2, s[56:59], s78 offen offset:3072 nt lds
    s_add_u32 m0, s72, 24576
    s_add_u32 s78, s91, 8192
    buffer_load_dwordx4 v2, s[56:59], s78 offen offset:0 nt lds
    buffer_load_dwordx4 v2, s[56:59], s78 offen offset:1024 nt lds
    buffer_load_dwordx4 v2, s[56:59], s78 offen offset:2048 nt lds
    buffer_load_dwordx4 v2, s[56:59], s78 offen offset:3072 nt lds
    s_add_u32 m0, s72, 28672
    s_add_u32 s78, s91, 12288
    buffer_load_dwordx4 v2, s[56:59], s78 offen offset:0 nt lds
    buffer_load_dwordx4 v2, s[56:59], s78 offen offset:1024 nt lds
    buffer_load_dwordx4 v2, s[56:59], s78 offen offset:2048 nt lds
    buffer_load_dwordx4 v2, s[56:59], s78 offen offset:3072 nt lds
    s_add_u32 m0, s72, 32768
    s_add_u32 s78, s91, 16384
    buffer_load_dwordx4 v2, s[56:59], s78 offen offset:0 nt lds
    buffer_load_dwordx4 v2, s[56:59], s78 offen offset:1024 nt lds
L_nodma_4:
L_w0_done:
    s_cmp_eq_u32 s3, 7
    s_cbranch_scc0 L_nogu3
    s_cmp_lt_u32 s69, 216
    s_cbranch_scc0 L_nogu3
    ds_read_b128 v[52:55], v2 offset:0
    ds_read_b128 v[56:59], v2 offset:1024
    ds_read_b128 v[60:63], v2 offset:2048
    ds_read_b128 v[64:67], v2 offset:3072
    ds_read_b128 v[68:71], v2 offset:4096
    ds_read_b128 v[72:75], v2 offset:5120
    v_lshlrev_b32 v6, 9, v150
    v_lshl_add_u32 v6, v151, 3, v6
    s_lshl_b32 s72, s69, 11
    s_add_u32 s72, s72, 327680
    s_waitcnt lgkmcnt(0)
    v_add_f32 v52, v52, v56
    v_add_f32 v53, v53, v57
    v_add_f32 v54, v54, v58
    v_add_f32 v55, v55, v59
    v_add_f32 v52, v52, v60
    v_add_f32 v53, v53, v61
    v_add_f32 v54, v54, v62
    v_add_f32 v55, v55, v63
    v_add_f32 v52, v52, v64
    v_add_f32 v53, v53, v65
    v_add_f32 v54, v54, v66
    v_add_f32 v55, v55, v67
    v_add_f32 v52, v52, v68
    v_add_f32 v53, v53, v69
    v_add_f32 v54, v54, v70
    v_add_f32 v55, v55, v71
    v_add_f32 v52, v52, v72
    v_add_f32 v53, v53, v73
    v_add_f32 v54, v54, v74
    v_add_f32 v55, v55, v75
    v_mov_b32 v8, v52
    v_mov_b32 v9, s90
    v_mov_b32 v10, v53
    v_mov_b32 v11, s90
    v_mov_b32 v12, v54
    v_mov_b32 v13, s90
    v_mov_b32 v14, v55
    v_mov_b32 v15, s90
    buffer_store_dwordx2 v[8:9], v6, s[64:67], s72 offen offset:0 sc1
    buffer_store_dwordx2 v[10:11], v6, s[64:67], s72 offen offset:128 sc1
    buffer_store_dwordx2 v[12:13], v6, s[64:67], s72 offen offset:256 sc1
    buffer_store_dwordx2 v[14:15], v6, s[64:67], s72 offen offset:384 sc1
L_nogu3:
    s_movk_i32 s72, 3
    s_bitcmp0_b32 s72, s3
    s_cselect_b32 s80, 0, s80
    s_cselect_b32 s19, 0, s19
    s_cselect_b32 s72, 0, 1
    v_mov_b32 v149, s72
    v_lshl_add_u32 v152, v151, 2, v150
    v_lshlrev_b32 v152, 7, v152
    s_lshl_b32 s72, s3, 10
    v_add_u32 v152, s72, v152
    s_lshl_b32 s72, s3, 4
    v_lshl_add_u32 v153, v151, 3, s72
    s_and_b32 s72, s3, 1
    s_lshl_b32 s72, s72, 6
    v_add_u32 v6, s72, v0
    v_lshrrev_b32 v7, 5, v6
    v_bfe_u32 v16, v6, 3, 2
    v_and_b32 v17, 7, v6
    v_lshlrev_b32 v7, 5, v7
    v_lshl_add_u32 v7, v17, 2, v7
    v_add_u32 v7, v7, v16
    s_bfe_u32 s13, s3, 0x10001
    s_lshl_b32 s72, s13, 9
    v_lshl_add_u32 v154, v7, 2, s72
    s_lshl_b32 s72, s13, 10
    v_lshl_add_u32 v155, v6, 3, s72
    s_mul_i32 s81, s2, 2176
    s_add_u32 s81, s81, 786432
    v_mov_b32 v52, 0
    v_mov_b32 v53, 0
    v_mov_b32 v54, 0
    v_mov_b32 v55, 0
    v_mov_b32 v56, 0
    v_mov_b32 v57, 0
    v_mov_b32 v58, 0
    v_mov_b32 v59, 0
    v_mov_b32 v60, 0
    v_mov_b32 v61, 0
    v_mov_b32 v62, 0
    v_mov_b32 v63, 0
    v_mov_b32 v64, 0
    v_mov_b32 v65, 0
    v_mov_b32 v66, 0
    v_mov_b32 v67, 0
    v_mov_b32 v68, 0
    v_mov_b32 v69, 0
    v_mov_b32 v70, 0
    v_mov_b32 v71, 0
    v_mov_b32 v72, 0
    v_mov_b32 v73, 0
    v_mov_b32 v74, 0
    v_mov_b32 v75, 0
    v_mov_b32 v76, 0
    v_mov_b32 v77, 0
    v_mov_b32 v78, 0
    v_mov_b32 v79, 0
    v_mov_b32 v80, 0
    v_mov_b32 v81, 0
    v_mov_b32 v82, 0
    v_mov_b32 v83, 0
    v_mov_b32 v3, 0xf149f2ca
    v_mov_b32 v4, 0
    s_waitcnt lgkmcnt(0)
L_loop:
    s_cmp_ge_u32 s98, 1024
    s_cbranch_scc1 L_loop_done
    s_cmp_lg_u32 s18, 0
    s_cbranch_scc1 L_pool_6
    s_mov_b64 exec, 1
    ds_add_rtn_u32 v15, v148, v149
    s_mov_b64 exec, -1
    s_branch L_grabbed_7
L_pool_6:
    s_mov_b32 s98, 1
    s_atomic_add s98, s[70:71], 0 glc
L_grabbed_7:
    s_waitcnt vmcnt(24)
    v_mfma_f32_16x16x32_bf16 v[16:19], a[0:3], v[36:39], 0
    v_mfma_f32_16x16x32_bf16 v[20:23], a[16:19], v[36:39], 0
    v_mfma_f32_16x16x32_bf16 v[16:19], a[4:7], v[40:43], v[16:19]
    v_mfma_f32_16x16x32_bf16 v[20:23], a[20:23], v[40:43], v[20:23]
    v_mfma_f32_16x16x32_bf16 v[16:19], a[8:11], v[44:47], v[16:19]
    v_mfma_f32_16x16x32_bf16 v[20:23], a[24:27], v[44:47], v[20:23]
    v_mfma_f32_16x16x32_bf16 v[16:19], a[12:15], v[48:51], v[16:19]
    v_mfma_f32_16x16x32_bf16 v[20:23], a[28:31], v[48:51], v[20:23]
    s_waitcnt lgkmcnt(0)
    s_cmp_lg_u32 s18, 0
    s_cbranch_scc1 L_chk_8
    v_readfirstlane_b32 s72, v15
    s_nop 3
    s_add_u32 s98, s72, s89
    s_cmp_lt_u32 s72, s80
    s_cbranch_scc1 L_have_5
    s_mov_b32 s98, 1024
    s_cmp_ge_u32 s72, s19
    s_cbranch_scc1 L_have_5
    s_mov_b32 s98, 1
    s_atomic_add s98, s[70:71], 0 glc
    s_mov_b32 s18, 1
    s_waitcnt lgkmcnt(0)
L_chk_8:
    s_cmp_lt_u32 s98, 1024
    s_cbranch_scc1 L_have_5
    s_mov_b32 s18, 0
    v_mov_b32 v15, 0x10000
    s_mov_b64 exec, 1
    ds_add_u32 v148, v15
    s_mov_b64 exec, -1
L_have_5:
    s_add_u32 s72, s98, s85
    s_and_b32 s72, s72, 1023
    s_lshl_b32 s72, s72, 13
    s_add_u32 s72, s72, s88
    s_cmp_lt_u32 s98, 1024
    s_cselect_b32 s94, s72, 1073741824
    s_add_u32 s95, s94, 4096
    buffer_load_dwordx4 a[0:3], v1, s[32:35], s94 offen offset:0 nt
    buffer_load_dwordx4 a[4:7], v1, s[32:35], s94 offen offset:64 nt
    buffer_load_dwordx4 a[8:11], v1, s[32:35], s94 offen offset:128 nt
    buffer_load_dwordx4 a[12:15], v1, s[32:35], s94 offen offset:192 nt
    buffer_load_dwordx4 a[16:19], v1, s[32:35], s95 offen offset:0 nt
    buffer_load_dwordx4 a[20:23], v1, s[32:35], s95 offen offset:64 nt
    buffer_load_dwordx4 a[24:27], v1, s[32:35], s95 offen offset:128 nt
    buffer_load_dwordx4 a[28:31], v1, s[32:35], s95 offen offset:192 nt
    v_cvt_pk_bf16_f32 v6, v16, v17
    v_cvt_pk_bf16_f32 v7, v18, v19
    v_cvt_pk_bf16_f32 v8, v20, v21
    v_cvt_pk_bf16_f32 v9, v22, v23
    v_lshlrev_b32 v16, 16, v6
    v_and_b32 v17, 0xffff0000, v6
    v_lshlrev_b32 v18, 16, v7
    v_and_b32 v19, 0xffff0000, v7
    v_lshlrev_b32 v20, 16, v8
    v_and_b32 v21, 0xffff0000, v8
    v_lshlrev_b32 v22, 16, v9
    v_and_b32 v23, 0xffff0000, v9
    v_mul_f32 v16, s86, v16
    v_mul_f32 v17, s86, v17
    v_mul_f32 v18, s86, v18
    v_mul_f32 v19, s86, v19
    v_mul_f32 v20, s86, v20
    v_mul_f32 v21, s86, v21
    v_mul_f32 v22, s86, v22
    v_mul_f32 v23, s86, v23
    v_cvt_pk_bf16_f32 v6, v16, v17
    v_cvt_pk_bf16_f32 v7, v18, v19
    v_cvt_pk_bf16_f32 v8, v20, v21
    v_cvt_pk_bf16_f32 v9, v22, v23
    v_lshlrev_b32 v16, 16, v6
    v_and_b32 v17, 0xffff0000, v6
    v_lshlrev_b32 v18, 16, v7
    v_and_b32 v19, 0xffff0000, v7
    v_lshlrev_b32 v20, 16, v8
    v_and_b32 v21, 0xffff0000, v8
    v_lshlrev_b32 v22, 16, v9
    v_and_b32 v23, 0xffff0000, v9
    v_max3_f32 v6, v16, v17, v18
    v_max3_f32 v7, v19, v20, v21
    v_max3_f32 v6, v6, v22, v23
    v_max3_f32 v6, v6, v7, v3
    v_mov_b32 v7, v6
    s_nop 1
    v_permlane16_swap_b32 v6, v7
    s_nop 1
    v_max_f32 v6, v6, v7
    v_mov_b32 v7, v6
    s_nop 1
    v_permlane32_swap_b32 v6, v7
    s_nop 1
    v_max_f32 v6, v6, v7
    v_sub_f32 v5, v3, v6
    v_mul_f32 v5, s87, v5
    v_exp_f32 v5, v5
    v_mov_b32 v3, v6
    v_mul_f32 v7, s87, v6
    v_fma_f32 v16, v16, s87, -v7
    v_fma_f32 v17, v17, s87, -v7
    v_fma_f32 v18, v18, s87, -v7
    v_fma_f32 v19, v19, s87, -v7
    v_fma_f32 v20, v20, s87, -v7
    v_fma_f32 v21, v21, s87, -v7
    v_fma_f32 v22, v22, s87, -v7
    v_fma_f32 v23, v23, s87, -v7
    v_exp_f32 v16, v16
    v_exp_f32 v17, v17
    v_exp_f32 v18, v18
    v_exp_f32 v19, v19
    v_exp_f32 v20, v20
    v_exp_f32 v21, v21
    v_exp_f32 v22, v22
    v_exp_f32 v23, v23
    v_cmp_neq_f32 vcc, 1.0, v5
    v_mul_f32 v4, v4, v5
    v_cvt_pk_bf16_f32 v24, v16, v17
    v_cvt_pk_bf16_f32 v25, v18, v19
    v_cvt_pk_bf16_f32 v26, v20, v21
    v_cvt_pk_bf16_f32 v27, v22, v23
    v_add_f32 v6, v16, v17
    v_add_f32 v7, v18, v19
    v_add_f32 v8, v20, v21
    v_add_f32 v9, v22, v23
    v_add_f32 v6, v6, v7
    v_add_f32 v8, v8, v9
    v_add_f32 v6, v6, v8
    v_add_f32 v4, v4, v6
    s_cbranch_vccz L_noscale_9
    v_mul_f32 v52, v52, v5
    v_mul_f32 v53, v53, v5
    v_mul_f32 v54, v54, v5
    v_mul_f32 v55, v55, v5
    v_mul_f32 v56, v56, v5
    v_mul_f32 v57, v57, v5
    v_mul_f32 v58, v58, v5
    v_mul_f32 v59, v59, v5
    v_mul_f32 v60, v60, v5
    v_mul_f32 v61, v61, v5
    v_mul_f32 v62, v62, v5
    v_mul_f32 v63, v63, v5
    v_mul_f32 v64, v64, v5
    v_mul_f32 v65, v65, v5
    v_mul_f32 v66, v66, v5
    v_mul_f32 v67, v67, v5
    v_mul_f32 v68, v68, v5
    v_mul_f32 v69, v69, v5
    v_mul_f32 v70, v70, v5
    v_mul_f32 v71, v71, v5
    v_mul_f32 v72, v72, v5
    v_mul_f32 v73, v73, v5
    v_mul_f32 v74, v74, v5
    v_mul_f32 v75, v75, v5
    v_mul_f32 v76, v76, v5
    v_mul_f32 v77, v77, v5
    v_mul_f32 v78, v78, v5
    v_mul_f32 v79, v79, v5
    v_mul_f32 v80, v80, v5
    v_mul_f32 v81, v81, v5
    v_mul_f32 v82, v82, v5
    v_mul_f32 v83, v83, v5
L_noscale_9:
    s_waitcnt vmcnt(24)
    v_perm_b32 v28, v88, v84, s82
    v_perm_b32 v29, v96, v92, s82
    v_perm_b32 v30, v104, v100, s82
    v_perm_b32 v31, v112, v108, s82
    s_nop 1
    v_mfma_f32_16x16x32_bf16 v[52:55], v[28:31], v[24:27], v[52:55]
    v_perm_b32 v32, v88, v84, s83
    v_perm_b32 v33, v96, v92, s83
    v_perm_b32 v34, v104, v100, s83
    v_perm_b32 v35, v112, v108, s83
    s_nop 1
    v_mfma_f32_16x16x32_bf16 v[56:59], v[32:35], v[24:27], v[56:59]
    v_perm_b32 v28, v89, v85, s82
    v_perm_b32 v29, v97, v93, s82
    v_perm_b32 v30, v105, v101, s82
    v_perm_b32 v31, v113, v109, s82
    s_nop 1
    v_mfma_f32_16x16x32_bf16 v[60:63], v[28:31], v[24:27], v[60:63]
    v_perm_b32 v32, v89, v85, s83
    v_perm_b32 v33, v97, v93, s83
    v_perm_b32 v34, v105, v101, s83
    v_perm_b32 v35, v113, v109, s83
    s_nop 1
    v_mfma_f32_16x16x32_bf16 v[64:67], v[32:35], v[24:27], v[64:67]
    v_perm_b32 v28, v90, v86, s82
    v_perm_b32 v29, v98, v94, s82
    v_perm_b32 v30, v106, v102, s82
    v_perm_b32 v31, v114, v110, s82
    s_nop 1
    v_mfma_f32_16x16x32_bf16 v[68:71], v[28:31], v[24:27], v[68:71]
    v_perm_b32 v32, v90, v86, s83
    v_perm_b32 v33, v98, v94, s83
    v_perm_b32 v34, v106, v102, s83
    v_perm_b32 v35, v114, v110, s83
    s_nop 1
    v_mfma_f32_16x16x32_bf16 v[72:75], v[32:35], v[24:27], v[72:75]
    v_perm_b32 v28, v91, v87, s82
    v_perm_b32 v29, v99, v95, s82
    v_perm_b32 v30, v107, v103, s82
    v_perm_b32 v31, v115, v111, s82
    s_nop 1
    v_mfma_f32_16x16x32_bf16 v[76:79], v[28:31], v[24:27], v[76:79]
    v_perm_b32 v32, v91, v87, s83
    v_perm_b32 v33, v99, v95, s83
    v_perm_b32 v34, v107, v103, s83
    v_perm_b32 v35, v115, v111, s83
    s_nop 1
    v_mfma_f32_16x16x32_bf16 v[80:83], v[32:35], v[24:27], v[80:83]
    buffer_load_dwordx4 v[84:87], v2, s[36:39], s94 offen offset:0 nt
    buffer_load_dwordx4 v[88:91], v2, s[36:39], s94 offen offset:1024 nt
    buffer_load_dwordx4 v[92:95], v2, s[36:39], s94 offen offset:2048 nt
    buffer_load_dwordx4 v[96:99], v2, s[36:39], s94 offen offset:3072 nt
    buffer_load_dwordx4 v[100:103], v2, s[36:39], s95 offen offset:0 nt
    buffer_load_dwordx4 v[104:107], v2, s[36:39], s95 offen offset:1024 nt
    buffer_load_dwordx4 v[108:111], v2, s[36:39], s95 offen offset:2048 nt
    buffer_load_dwordx4 v[112:115], v2, s[36:39], s95 offen offset:3072 nt
    s_cmp_ge_u32 s99, 1024
    s_cbranch_scc1 L_loop_done
    s_cmp_lg_u32 s18, 0
    s_cbranch_scc1 L_pool_11
    s_mov_b64 exec, 1
    ds_add_rtn_u32 v15, v148, v149
    s_mov_b64 exec, -1
    s_branch L_grabbed_12
L_pool_11:
    s_mov_b32 s99, 1
    s_atomic_add s99, s[70:71], 0 glc
L_grabbed_12:
    s_waitcnt vmcnt(24)
    v_mfma_f32_16x16x32_bf16 v[16:19], a[32:35], v[36:39], 0
    v_mfma_f32_16x16x32_bf16 v[20:23], a[48:51], v[36:39], 0
    v_mfma_f32_16x16x32_bf16 v[16:19], a[36:39], v[40:43], v[16:19]
    v_mfma_f32_16x16x32_bf16 v[20:23], a[52:55], v[40:43], v[20:23]
    v_mfma_f32_16x16x32_bf16 v[16:19], a[40:43], v[44:47], v[16:19]
    v_mfma_f32_16x16x32_bf16 v[20:23], a[56:59], v[44:47], v[20:23]
    v_mfma_f32_16x16x32_bf16 v[16:19], a[44:47], v[48:51], v[16:19]
    v_mfma_f32_16x16x32_bf16 v[20:23], a[60:63], v[48:51], v[20:23]
    s_waitcnt lgkmcnt(0)
    s_cmp_lg_u32 s18, 0
    s_cbranch_scc1 L_chk_13
    v_readfirstlane_b32 s72, v15
    s_nop 3
    s_add_u32 s99, s72, s89
    s_cmp_lt_u32 s72, s80
    s_cbranch_scc1 L_have_10
    s_mov_b32 s99, 1024
    s_cmp_ge_u32 s72, s19
    s_cbranch_scc1 L_have_10
    s_mov_b32 s99, 1
    s_atomic_add s99, s[70:71], 0 glc
    s_mov_b32 s18, 1
    s_waitcnt lgkmcnt(0)
L_chk_13:
    s_cmp_lt_u32 s99, 1024
    s_cbranch_scc1 L_have_10
    s_mov_b32 s18, 0
    v_mov_b32 v15, 0x10000
    s_mov_b64 exec, 1
    ds_add_u32 v148, v15
    s_mov_b64 exec, -1
L_have_10:
    s_add_u32 s72, s99, s85
    s_and_b32 s72, s72, 1023
    s_lshl_b32 s72, s72, 13
    s_add_u32 s72, s72, s88
    s_cmp_lt_u32 s99, 1024
    s_cselect_b32 s96, s72, 1073741824
    s_add_u32 s97, s96, 4096
    buffer_load_dwordx4 a[32:35], v1, s[32:35], s96 offen offset:0 nt
    buffer_load_dwordx4 a[36:39], v1, s[32:35], s96 offen offset:64 nt
    buffer_load_dwordx4 a[40:43], v1, s[32:35], s96 offen offset:128 nt
    buffer_load_dwordx4 a[44:47], v1, s[32:35], s96 offen offset:192 nt
    buffer_load_dwordx4 a[48:51], v1, s[32:35], s97 offen offset:0 nt
    buffer_load_dwordx4 a[52:55], v1, s[32:35], s97 offen offset:64 nt
    buffer_load_dwordx4 a[56:59], v1, s[32:35], s97 offen offset:128 nt
    buffer_load_dwordx4 a[60:63], v1, s[32:35], s97 offen offset:192 nt
    v_cvt_pk_bf16_f32 v6, v16, v17
    v_cvt_pk_bf16_f32 v7, v18, v19
    v_cvt_pk_bf16_f32 v8, v20, v21
    v_cvt_pk_bf16_f32 v9, v22, v23
    v_lshlrev_b32 v16, 16, v6
    v_and_b32 v17, 0xffff0000, v6
    v_lshlrev_b32 v18, 16, v7
    v_and_b32 v19, 0xffff0000, v7
    v_lshlrev_b32 v20, 16, v8
    v_and_b32 v21, 0xffff0000, v8
    v_lshlrev_b32 v22, 16, v9
    v_and_b32 v23, 0xffff0000, v9
    v_mul_f32 v16, s86, v16
    v_mul_f32 v17, s86, v17
    v_mul_f32 v18, s86, v18
    v_mul_f32 v19, s86, v19
    v_mul_f32 v20, s86, v20
    v_mul_f32 v21, s86, v21
    v_mul_f32 v22, s86, v22
    v_mul_f32 v23, s86, v23
    v_cvt_pk_bf16_f32 v6, v16, v17
    v_cvt_pk_bf16_f32 v7, v18, v19
    v_cvt_pk_bf16_f32 v8, v20, v21
    v_cvt_pk_bf16_f32 v9, v22, v23
    v_lshlrev_b32 v16, 16, v6
    v_and_b32 v17, 0xffff0000, v6
    v_lshlrev_b32 v18, 16, v7
    v_and_b32 v19, 0xffff0000, v7
    v_lshlrev_b32 v20, 16, v8
    v_and_b32 v21, 0xffff0000, v8
    v_lshlrev_b32 v22, 16, v9
    v_and_b32 v23, 0xffff0000, v9
    v_max3_f32 v6, v16, v17, v18
    v_max3_f32 v7, v19, v20, v21
    v_max3_f32 v6, v6, v22, v23
    v_max3_f32 v6, v6, v7, v3
    v_mov_b32 v7, v6
    s_nop 1
    v_permlane16_swap_b32 v6, v7
    s_nop 1
    v_max_f32 v6, v6, v7
    v_mov_b32 v7, v6
    s_nop 1
    v_permlane32_swap_b32 v6, v7
    s_nop 1
    v_max_f32 v6, v6, v7
    v_sub_f32 v5, v3, v6
    v_mul_f32 v5, s87, v5
    v_exp_f32 v5, v5
    v_mov_b32 v3, v6
    v_mul_f32 v7, s87, v6
    v_fma_f32 v16, v16, s87, -v7
    v_fma_f32 v17, v17, s87, -v7
    v_fma_f32 v18, v18, s87, -v7
    v_fma_f32 v19, v19, s87, -v7
    v_fma_f32 v20, v20, s87, -v7
    v_fma_f32 v21, v21, s87, -v7
    v_fma_f32 v22, v22, s87, -v7
    v_fma_f32 v23, v23, s87, -v7
    v_exp_f32 v16, v16
    v_exp_f32 v17, v17
    v_exp_f32 v18, v18
    v_exp_f32 v19, v19
    v_exp_f32 v20, v20
    v_exp_f32 v21, v21
    v_exp_f32 v22, v22
    v_exp_f32 v23, v23
    v_cmp_neq_f32 vcc, 1.0, v5
    v_mul_f32 v4, v4, v5
    v_cvt_pk_bf16_f32 v24, v16, v17
    v_cvt_pk_bf16_f32 v25, v18, v19
    v_cvt_pk_bf16_f32 v26, v20, v21
    v_cvt_pk_bf16_f32 v27, v22, v23
    v_add_f32 v6, v16, v17
    v_add_f32 v7, v18, v19
    v_add_f32 v8, v20, v21
    v_add_f32 v9, v22, v23
    v_add_f32 v6, v6, v7
    v_add_f32 v8, v8, v9
    v_add_f32 v6, v6, v8
    v_add_f32 v4, v4, v6
    s_cbranch_vccz L_noscale_14
    v_mul_f32 v52, v52, v5
    v_mul_f32 v53, v53, v5
    v_mul_f32 v54, v54, v5
    v_mul_f32 v55, v55, v5
    v_mul_f32 v56, v56, v5
    v_mul_f32 v57, v57, v5
    v_mul_f32 v58, v58, v5
    v_mul_f32 v59, v59, v5
    v_mul_f32 v60, v60, v5
    v_mul_f32 v61, v61, v5
    v_mul_f32 v62, v62, v5
    v_mul_f32 v63, v63, v5
    v_mul_f32 v64, v64, v5
    v_mul_f32 v65, v65, v5
    v_mul_f32 v66, v66, v5
    v_mul_f32 v67, v67, v5
    v_mul_f32 v68, v68, v5
    v_mul_f32 v69, v69, v5
    v_mul_f32 v70, v70, v5
    v_mul_f32 v71, v71, v5
    v_mul_f32 v72, v72, v5
    v_mul_f32 v73, v73, v5
    v_mul_f32 v74, v74, v5
    v_mul_f32 v75, v75, v5
    v_mul_f32 v76, v76, v5
    v_mul_f32 v77, v77, v5
    v_mul_f32 v78, v78, v5
    v_mul_f32 v79, v79, v5
    v_mul_f32 v80, v80, v5
    v_mul_f32 v81, v81, v5
    v_mul_f32 v82, v82, v5
    v_mul_f32 v83, v83, v5
L_noscale_14:
    s_waitcnt vmcnt(24)
    v_perm_b32 v28, v120, v116, s82
    v_perm_b32 v29, v128, v124, s82
    v_perm_b32 v30, v136, v132, s82
    v_perm_b32 v31, v144, v140, s82
    s_nop 1
    v_mfma_f32_16x16x32_bf16 v[52:55], v[28:31], v[24:27], v[52:55]
    v_perm_b32 v32, v120, v116, s83
    v_perm_b32 v33, v128, v124, s83
    v_perm_b32 v34, v136, v132, s83
    v_perm_b32 v35, v144, v140, s83
    s_nop 1
    v_mfma_f32_16x16x32_bf16 v[56:59], v[32:35], v[24:27], v[56:59]
    v_perm_b32 v28, v121, v117, s82
    v_perm_b32 v29, v129, v125, s82
    v_perm_b32 v30, v137, v133, s82
    v_perm_b32 v31, v145, v141, s82
    s_nop 1
    v_mfma_f32_16x16x32_bf16 v[60:63], v[28:31], v[24:27], v[60:63]
    v_perm_b32 v32, v121, v117, s83
    v_perm_b32 v33, v129, v125, s83
    v_perm_b32 v34, v137, v133, s83
    v_perm_b32 v35, v145, v141, s83
    s_nop 1
    v_mfma_f32_16x16x32_bf16 v[64:67], v[32:35], v[24:27], v[64:67]
    v_perm_b32 v28, v122, v118, s82
    v_perm_b32 v29, v130, v126, s82
    v_perm_b32 v30, v138, v134, s82
    v_perm_b32 v31, v146, v142, s82
    s_nop 1
    v_mfma_f32_16x16x32_bf16 v[68:71], v[28:31], v[24:27], v[68:71]
    v_perm_b32 v32, v122, v118, s83
    v_perm_b32 v33, v130, v126, s83
    v_perm_b32 v34, v138, v134, s83
    v_perm_b32 v35, v146, v142, s83
    s_nop 1
    v_mfma_f32_16x16x32_bf16 v[72:75], v[32:35], v[24:27], v[72:75]
    v_perm_b32 v28, v123, v119, s82
    v_perm_b32 v29, v131, v127, s82
    v_perm_b32 v30, v139, v135, s82
    v_perm_b32 v31, v147, v143, s82
    s_nop 1
    v_mfma_f32_16x16x32_bf16 v[76:79], v[28:31], v[24:27], v[76:79]
    v_perm_b32 v32, v123, v119, s83
    v_perm_b32 v33, v131, v127, s83
    v_perm_b32 v34, v139, v135, s83
    v_perm_b32 v35, v147, v143, s83
    s_nop 1
    v_mfma_f32_16x16x32_bf16 v[80:83], v[32:35], v[24:27], v[80:83]
    buffer_load_dwordx4 v[116:119], v2, s[36:39], s96 offen offset:0 nt
    buffer_load_dwordx4 v[120:123], v2, s[36:39], s96 offen offset:1024 nt
    buffer_load_dwordx4 v[124:127], v2, s[36:39], s96 offen offset:2048 nt
    buffer_load_dwordx4 v[128:131], v2, s[36:39], s96 offen offset:3072 nt
    buffer_load_dwordx4 v[132:135], v2, s[36:39], s97 offen offset:0 nt
    buffer_load_dwordx4 v[136:139], v2, s[36:39], s97 offen offset:1024 nt
    buffer_load_dwordx4 v[140:143], v2, s[36:39], s97 offen offset:2048 nt
    buffer_load_dwordx4 v[144:147], v2, s[36:39], s97 offen offset:3072 nt
    s_branch L_loop
L_loop_done:
    s_mov_b32 exec_lo, 0x00030003
    s_mov_b32 exec_hi, 0x00030003
    ds_write_b128 v152, v[52:55] offset:7424
    ds_write_b128 v152, v[56:59] offset:7440
    ds_write_b128 v152, v[60:63] offset:7456
    ds_write_b128 v152, v[64:67] offset:7472
    ds_write_b128 v152, v[68:71] offset:7488
    ds_write_b128 v152, v[72:75] offset:7504
    ds_write_b128 v152, v[76:79] offset:7520
    ds_write_b128 v152, v[80:83] offset:7536
    s_mov_b64 exec, -1
    v_mov_b32 v6, v4
    s_nop 1
    v_permlane16_swap_b32 v4, v6
    s_nop 1
    v_add_f32 v4, v4, v6
    v_mov_b32 v6, v4
    s_nop 1
    v_permlane32_swap_b32 v4, v6
    s_nop 1
    v_add_f32 v4, v4, v6
    v_mov_b32 v10, v3
    v_mov_b32 v11, v4
    s_mov_b64 exec, 3
    ds_write_b64 v153, v[10:11] offset:15616
    s_mov_b64 exec, -1
    s_lshl_b32 s72, s13, 3
    v_mov_b32 v8, s72
    s_lshl_b32 s72, s13, 4
    v_mov_b32 v7, s72
    v_mov_b32 v13, s90
    v_mov_b32 v41, s90
    v_mov_b32 v43, s90
    s_waitcnt vmcnt(0) lgkmcnt(0)
    s_barrier
    s_cmp_lt_u32 s3, 4
    s_cbranch_scc0 L_nopub
    ds_read_b64 v[24:25], v8 offset:15616
    ds_read_b64 v[26:27], v8 offset:15632
    ds_read_b64 v[28:29], v8 offset:15648
    ds_read_b64 v[30:31], v8 offset:15664
    ds_read_b64 v[32:33], v8 offset:15680
    ds_read_b64 v[34:35], v8 offset:15696
    ds_read_b64 v[36:37], v8 offset:15712
    ds_read_b64 v[38:39], v8 offset:15728
    ds_read_b32 v16, v154 offset:7424
    ds_read_b32 v17, v154 offset:8448
    ds_read_b32 v18, v154 offset:9472
    ds_read_b32 v19, v154 offset:10496
    ds_read_b32 v20, v154 offset:11520
    ds_read_b32 v21, v154 offset:12544
    ds_read_b32 v22, v154 offset:13568
    ds_read_b32 v23, v154 offset:14592
    s_waitcnt lgkmcnt(8)
    v_max3_f32 v40, v24, v26, v28
    v_max3_f32 v9, v30, v32, v34
    v_max3_f32 v40, v40, v36, v38
    v_max_f32 v40, v40, v9
    v_mul_f32 v9, s87, v40
    v_fma_f32 v24, v24, s87, -v9
    v_fma_f32 v26, v26, s87, -v9
    v_fma_f32 v28, v28, s87, -v9
    v_fma_f32 v30, v30, s87, -v9
    v_fma_f32 v32, v32, s87, -v9
    v_fma_f32 v34, v34, s87, -v9
    v_fma_f32 v36, v36, s87, -v9
    v_fma_f32 v38, v38, s87, -v9
    v_exp_f32 v24, v24
    v_exp_f32 v26, v26
    v_exp_f32 v28, v28
    v_exp_f32 v30, v30
    v_exp_f32 v32, v32
    v_exp_f32 v34, v34
    v_exp_f32 v36, v36
    v_exp_f32 v38, v38
    s_waitcnt lgkmcnt(0)
    v_mul_f32 v12, v16, v24
    v_mul_f32 v14, v17, v26
    v_fmac_f32 v12, v18, v28
    v_fmac_f32 v14, v19, v30
    v_fmac_f32 v12, v20, v32
    v_fmac_f32 v14, v21, v34
    v_fmac_f32 v12, v22, v36
    v_fmac_f32 v14, v23, v38
    v_add_f32 v12, v12, v14
    buffer_store_dwordx2 v[12:13], v155, s[64:67], s81 offen sc1
    v_mul_f32 v42, v25, v24
    v_fmac_f32 v42, v27, v26
    v_fmac_f32 v42, v29, v28
    v_fmac_f32 v42, v31, v30
    v_fmac_f32 v42, v33, v32
    v_fmac_f32 v42, v35, v34
    v_fmac_f32 v42, v37, v36
    v_fmac_f32 v42, v39, v38
    s_mov_b64 exec, 1
    buffer_store_dwordx4 v[40:43], v7, s[64:67], s81 offen offset:2048 sc1
    s_mov_b64 exec, -1
L_nopub:
    s_cmp_lt_u32 s68, 100
    s_cbranch_scc0 L_notcomb
    s_cmp_eq_u32 s3, 7
    s_cbranch_scc1 L_finish
    s_and_b32 s72, s3, 6
    s_cmp_eq_u32 s72, 4
    s_cbranch_scc1 L_gather
    s_min_u32 s73, s3, 4
    v_mul_u32_u24 v46, 9216, v150
    s_lshl_b32 s72, s73, 4
    v_add_u32 v47, s72, v151
    v_min_u32 v47, 71, v47
    v_lshl_add_u32 v46, v47, 4, v46
    v_add_u32 v46, 16384, v46
    ds_read_b128 v[48:51], v46 offset:0
    ds_read_b128 v[52:55], v46 offset:1152
    ds_read_b128 v[56:59], v46 offset:2304
    ds_read_b128 v[60:63], v46 offset:3456
    ds_read_b128 v[64:67], v46 offset:4608
    ds_read_b128 v[68:71], v46 offset:5760
    ds_read_b128 v[72:75], v46 offset:6912
    ds_read_b128 v[76:79], v46 offset:8064
    v_add_u32 v46, 36864, v46
    s_waitcnt lgkmcnt(0)
    v_perm_b32 v84, v52, v48, s82
    v_perm_b32 v85, v60, v56, s82
    v_perm_b32 v86, v68, v64, s82
    v_perm_b32 v87, v76, v72, s82
    v_perm_b32 v88, v52, v48, s83
    v_perm_b32 v89, v60, v56, s83
    v_perm_b32 v90, v68, v64, s83
    v_perm_b32 v91, v76, v72, s83
    v_perm_b32 v92, v53, v49, s82
    v_perm_b32 v93, v61, v57, s82
    v_perm_b32 v94, v69, v65, s82
    v_perm_b32 v95, v77, v73, s82
    v_perm_b32 v96, v53, v49, s83
    v_perm_b32 v97, v61, v57, s83
    v_perm_b32 v98, v69, v65, s83
    v_perm_b32 v99, v77, v73, s83
    v_perm_b32 v100, v54, v50, s82
    v_perm_b32 v101, v62, v58, s82
    v_perm_b32 v102, v70, v66, s82
    v_perm_b32 v103, v78, v74, s82
    v_perm_b32 v104, v54, v50, s83
    v_perm_b32 v105, v62, v58, s83
    v_perm_b32 v106, v70, v66, s83
    v_perm_b32 v107, v78, v74, s83
    v_perm_b32 v108, v55, v51, s82
    v_perm_b32 v109, v63, v59, s82
    v_perm_b32 v110, v71, v67, s82
    v_perm_b32 v111, v79, v75, s82
    v_perm_b32 v112, v55, v51, s83
    v_perm_b32 v113, v63, v59, s83
    v_perm_b32 v114, v71, v67, s83
    v_perm_b32 v115, v79, v75, s83
    ds_read_b128 v[48:51], v46 offset:0
    ds_read_b128 v[52:55], v46 offset:1152
    ds_read_b128 v[56:59], v46 offset:2304
    ds_read_b128 v[60:63], v46 offset:3456
    ds_read_b128 v[64:67], v46 offset:4608
    ds_read_b128 v[68:71], v46 offset:5760
    ds_read_b128 v[72:75], v46 offset:6912
    ds_read_b128 v[76:79], v46 offset:8064
    v_add_u32 v46, 36864, v46
    s_waitcnt lgkmcnt(0)
    v_perm_b32 v116, v52, v48, s82
    v_perm_b32 v117, v60, v56, s82
    v_perm_b32 v118, v68, v64, s82
    v_perm_b32 v119, v76, v72, s82
    v_perm_b32 v120, v52, v48, s83
    v_perm_b32 v121, v60, v56, s83
    v_perm_b32 v122, v68, v64, s83
    v_perm_b32 v123, v76, v72, s83
    v_perm_b32 v124, v53, v49, s82
    v_perm_b32 v125, v61, v57, s82
    v_perm_b32 v126, v69, v65, s82
    v_perm_b32 v127, v77, v73, s82
    v_perm_b32 v128, v53, v49, s83
    v_perm_b32 v129, v61, v57, s83
    v_perm_b32 v130, v69, v65, s83
    v_perm_b32 v131, v77, v73, s83
    v_perm_b32 v132, v54, v50, s82
    v_perm_b32 v133, v62, v58, s82
    v_perm_b32 v134, v70, v66, s82
    v_perm_b32 v135, v78, v74, s82
    v_perm_b32 v136, v54, v50, s83
    v_perm_b32 v137, v62, v58, s83
    v_perm_b32 v138, v70, v66, s83
    v_perm_b32 v139, v78, v74, s83
    v_perm_b32 v140, v55, v51, s82
    v_perm_b32 v141, v63, v59, s82
    v_perm_b32 v142, v71, v67, s82
    v_perm_b32 v143, v79, v75, s82
    v_perm_b32 v144, v55, v51, s83
    v_perm_b32 v145, v63, v59, s83
    v_perm_b32 v146, v71, v67, s83
    v_perm_b32 v147, v79, v75, s83
    s_cmp_lt_u32 s68, 64
    s_cbranch_scc1 L_prep_done
    ds_read_b128 v[48:51], v46 offset:0
    ds_read_b128 v[52:55], v46 offset:1152
    ds_read_b128 v[56:59], v46 offset:2304
    ds_read_b128 v[60:63], v46 offset:3456
    ds_read_b128 v[64:67], v46 offset:4608
    ds_read_b128 v[68:71], v46 offset:5760
    ds_read_b128 v[72:75], v46 offset:6912
    ds_read_b128 v[76:79], v46 offset:8064
    v_add_u32 v46, 36864, v46
    s_waitcnt lgkmcnt(0)
    v_perm_b32 v8, v52, v48, s82
    v_perm_b32 v9, v60, v56, s82
    v_perm_b32 v10, v68, v64, s82
    v_perm_b32 v11, v76, v72, s82
    v_accvgpr_write_b32 a0, v8
    v_accvgpr_write_b32 a1, v9
    v_accvgpr_write_b32 a2, v10
    v_accvgpr_write_b32 a3, v11
    v_perm_b32 v8, v52, v48, s83
    v_perm_b32 v9, v60, v56, s83
    v_perm_b32 v10, v68, v64, s83
    v_perm_b32 v11, v76, v72, s83
    v_accvgpr_write_b32 a4, v8
    v_accvgpr_write_b32 a5, v9
    v_accvgpr_write_b32 a6, v10
    v_accvgpr_write_b32 a7, v11
    v_perm_b32 v8, v53, v49, s82
    v_perm_b32 v9, v61, v57, s82
    v_perm_b32 v10, v69, v65, s82
    v_perm_b32 v11, v77, v73, s82
    v_accvgpr_write_b32 a8, v8
    v_accvgpr_write_b32 a9, v9
    v_accvgpr_write_b32 a10, v10
    v_accvgpr_write_b32 a11, v11
    v_perm_b32 v8, v53, v49, s83
    v_perm_b32 v9, v61, v57, s83
    v_perm_b32 v10, v69, v65, s83
    v_perm_b32 v11, v77, v73, s83
    v_accvgpr_write_b32 a12, v8
    v_accvgpr_write_b32 a13, v9
    v_accvgpr_write_b32 a14, v10
    v_accvgpr_write_b32 a15, v11
    v_perm_b32 v8, v54, v50, s82
    v_perm_b32 v9, v62, v58, s82
    v_perm_b32 v10, v70, v66, s82
    v_perm_b32 v11, v78, v74, s82
    v_accvgpr_write_b32 a16, v8
    v_accvgpr_write_b32 a17, v9
    v_accvgpr_write_b32 a18, v10
    v_accvgpr_write_b32 a19, v11
    v_perm_b32 v8, v54, v50, s83
    v_perm_b32 v9, v62, v58, s83
    v_perm_b32 v10, v70, v66, s83
    v_perm_b32 v11, v78, v74, s83
    v_accvgpr_write_b32 a20, v8
    v_accvgpr_write_b32 a21, v9
    v_accvgpr_write_b32 a22, v10
    v_accvgpr_write_b32 a23, v11
    v_perm_b32 v8, v55, v51, s82
    v_perm_b32 v9, v63, v59, s82
    v_perm_b32 v10, v71, v67, s82
    v_perm_b32 v11, v79, v75, s82
    v_accvgpr_write_b32 a24, v8
    v_accvgpr_write_b32 a25, v9
    v_accvgpr_write_b32 a26, v10
    v_accvgpr_write_b32 a27, v11
    v_perm_b32 v8, v55, v51, s83
    v_perm_b32 v9, v63, v59, s83
    v_perm_b32 v10, v71, v67, s83
    v_perm_b32 v11, v79, v75, s83
    v_accvgpr_write_b32 a28, v8
    v_accvgpr_write_b32 a29, v9
    v_accvgpr_write_b32 a30, v10
    v_accvgpr_write_b32 a31, v11
    ds_read_b128 v[48:51], v46 offset:0
    ds_read_b128 v[52:55], v46 offset:1152
    ds_read_b128 v[56:59], v46 offset:2304
    ds_read_b128 v[60:63], v46 offset:3456
    ds_read_b128 v[64:67], v46 offset:4608
    ds_read_b128 v[68:71], v46 offset:5760
    ds_read_b128 v[72:75], v46 offset:6912
    ds_read_b128 v[76:79], v46 offset:8064
    v_add_u32 v46, 36864, v46
    s_waitcnt lgkmcnt(0)
    v_perm_b32 v8, v52, v48, s82
    v_perm_b32 v9, v60, v56, s82
    v_perm_b32 v10, v68, v64, s82
    v_perm_b32 v11, v76, v72, s82
    v_accvgpr_write_b32 a32, v8
    v_accvgpr_write_b32 a33, v9
    v_accvgpr_write_b32 a34, v10
    v_accvgpr_write_b32 a35, v11
    v_perm_b32 v8, v52, v48, s83
    v_perm_b32 v9, v60, v56, s83
    v_perm_b32 v10, v68, v64, s83
    v_perm_b32 v11, v76, v72, s83
    v_accvgpr_write_b32 a36, v8
    v_accvgpr_write_b32 a37, v9
    v_accvgpr_write_b32 a38, v10
    v_accvgpr_write_b32 a39, v11
    v_perm_b32 v8, v53, v49, s82
    v_perm_b32 v9, v61, v57, s82
    v_perm_b32 v10, v69, v65, s82
    v_perm_b32 v11, v77, v73, s82
    v_accvgpr_write_b32 a40, v8
    v_accvgpr_write_b32 a41, v9
    v_accvgpr_write_b32 a42, v10
    v_accvgpr_write_b32 a43, v11
    v_perm_b32 v8, v53, v49, s83
    v_perm_b32 v9, v61, v57, s83
    v_perm_b32 v10, v69, v65, s83
    v_perm_b32 v11, v77, v73, s83
    v_accvgpr_write_b32 a44, v8
    v_accvgpr_write_b32 a45, v9
    v_accvgpr_write_b32 a46, v10
    v_accvgpr_write_b32 a47, v11
    v_perm_b32 v8, v54, v50, s82
    v_perm_b32 v9, v62, v58, s82
    v_perm_b32 v10, v70, v66, s82
    v_perm_b32 v11, v78, v74, s82
    v_accvgpr_write_b32 a48, v8
    v_accvgpr_write_b32 a49, v9
    v_accvgpr_write_b32 a50, v10
    v_accvgpr_write_b32 a51, v11
    v_perm_b32 v8, v54, v50, s83
    v_perm_b32 v9, v62, v58, s83
    v_perm_b32 v10, v70, v66, s83
    v_perm_b32 v11, v78, v74, s83
    v_accvgpr_write_b32 a52, v8
    v_accvgpr_write_b32 a53, v9
    v_accvgpr_write_b32 a54, v10
    v_accvgpr_write_b32 a55, v11
    v_perm_b32 v8, v55, v51, s82
    v_perm_b32 v9, v63, v59, s82
    v_perm_b32 v10, v71, v67, s82
    v_perm_b32 v11, v79, v75, s82
    v_accvgpr_write_b32 a56, v8
    v_accvgpr_write_b32 a57, v9
    v_accvgpr_write_b32 a58, v10
    v_accvgpr_write_b32 a59, v11
    v_perm_b32 v8, v55, v51, s83
    v_perm_b32 v9, v63, v59, s83
    v_perm_b32 v10, v71, v67, s83
    v_perm_b32 v11, v79, v75, s83
    v_accvgpr_write_b32 a60, v8
    v_accvgpr_write_b32 a61, v9
    v_accvgpr_write_b32 a62, v10
    v_accvgpr_write_b32 a63, v11
L_prep_done:
    v_and_b32 v8, 2, v151
    v_cmp_ne_u32 s[4:5], 0, v8
    v_and_b32 v8, 4, v151
    v_cmp_ne_u32 s[6:7], 0, v8
    v_and_b32 v8, 8, v151
    v_cmp_ne_u32 s[8:9], 0, v8
    s_lshl_b32 s72, s73, 7
    v_lshl_add_u32 v46, v150, 5, s72
    v_mov_b32 v8, 576
    v_cmp_lt_u32 s[10:11], v46, v8
    v_lshlrev_b32 v46, 4, v46
    v_lshl_add_u32 v46, v151, 3, v46
    s_mul_i32 s72, s68, 9216
    s_add_u32 s72, s72, 1376256
    v_and_b32 v47, 1, v0
    v_lshlrev_b32 v47, 8, v47
    v_lshl_add_u32 v47, v150, 4, v47
    v_mov_b32 v25, s90
    v_mov_b32 v27, s90
    v_mov_b32 v29, s90
    v_mov_b32 v31, s90
    s_barrier
    ds_read_b128 v[8:11], v47 offset:6720
    ds_read_b128 v[12:15], v47 offset:6784
    ds_read_b128 v[16:19], v47 offset:6848
    ds_read_b128 v[20:23], v47 offset:6912
    s_waitcnt lgkmcnt(3)
    v_mfma_f32_16x16x32_bf16 v[48:51], v[84:87], v[8:11], 0
    v_mfma_f32_16x16x32_bf16 v[52:55], v[88:91], v[8:11], 0
    v_mfma_f32_16x16x32_bf16 v[56:59], v[92:95], v[8:11], 0
    v_mfma_f32_16x16x32_bf16 v[60:63], v[96:99], v[8:11], 0
    v_mfma_f32_16x16x32_bf16 v[64:67], v[100:103], v[8:11], 0
    v_mfma_f32_16x16x32_bf16 v[68:71], v[104:107], v[8:11], 0
    v_mfma_f32_16x16x32_bf16 v[72:75], v[108:111], v[8:11], 0
    v_mfma_f32_16x16x32_bf16 v[76:79], v[112:115], v[8:11], 0
    s_waitcnt lgkmcnt(2)
    v_mfma_f32_16x16x32_bf16 v[48:51], v[116:119], v[12:15], v[48:51]
    v_mfma_f32_16x16x32_bf16 v[52:55], v[120:123], v[12:15], v[52:55]
    v_mfma_f32_16x16x32_bf16 v[56:59], v[124:127], v[12:15], v[56:59]
    v_mfma_f32_16x16x32_bf16 v[60:63], v[128:131], v[12:15], v[60:63]
    v_mfma_f32_16x16x32_bf16 v[64:67], v[132:135], v[12:15], v[64:67]
    v_mfma_f32_16x16x32_bf16 v[68:71], v[136:139], v[12:15], v[68:71]
    v_mfma_f32_16x16x32_bf16 v[72:75], v[140:143], v[12:15], v[72:75]
    v_mfma_f32_16x16x32_bf16 v[76:79], v[144:147], v[12:15], v[76:79]
    s_cmp_lt_u32 s68, 64
    s_cbranch_scc1 L_mm_done
    s_waitcnt lgkmcnt(1)
    v_mfma_f32_16x16x32_bf16 v[48:51], a[0:3], v[16:19], v[48:51]
    v_mfma_f32_16x16x32_bf16 v[52:55], a[4:7], v[16:19], v[52:55]
    v_mfma_f32_16x16x32_bf16 v[56:59], a[8:11], v[16:19], v[56:59]
    v_mfma_f32_16x16x32_bf16 v[60:63], a[12:15], v[16:19], v[60:63]
    v_mfma_f32_16x16x32_bf16 v[64:67], a[16:19], v[16:19], v[64:67]
    v_mfma_f32_16x16x32_bf16 v[68:71], a[20:23], v[16:19], v[68:71]
    v_mfma_f32_16x16x32_bf16 v[72:75], a[24:27], v[16:19], v[72:75]
    v_mfma_f32_16x16x32_bf16 v[76:79], a[28:31], v[16:19], v[76:79]
    s_waitcnt lgkmcnt(0)
    v_mfma_f32_16x16x32_bf16 v[48:51], a[32:35], v[20:23], v[48:51]
    v_mfma_f32_16x16x32_bf16 v[52:55], a[36:39], v[20:23], v[52:55]
    v_mfma_f32_16x16x32_bf16 v[56:59], a[40:43], v[20:23], v[56:59]
    v_mfma_f32_16x16x32_bf16 v[60:63], a[44:47], v[20:23], v[60:63]
    v_mfma_f32_16x16x32_bf16 v[64:67], a[48:51], v[20:23], v[64:67]
    v_mfma_f32_16x16x32_bf16 v[68:71], a[52:55], v[20:23], v[68:71]
    v_mfma_f32_16x16x32_bf16 v[72:75], a[56:59], v[20:23], v[72:75]
    v_mfma_f32_16x16x32_bf16 v[76:79], a[60:63], v[20:23], v[76:79]
L_mm_done:
    s_nop 6
    v_cndmask_b32 v48, v48, v52, s[4:5]
    v_cndmask_b32 v49, v49, v53, s[4:5]
    v_cndmask_b32 v50, v50, v54, s[4:5]
    v_cndmask_b32 v51, v51, v55, s[4:5]
    v_cndmask_b32 v56, v56, v60, s[4:5]
    v_cndmask_b32 v57, v57, v61, s[4:5]
    v_cndmask_b32 v58, v58, v62, s[4:5]
    v_cndmask_b32 v59, v59, v63, s[4:5]
    v_cndmask_b32 v64, v64, v68, s[4:5]
    v_cndmask_b32 v65, v65, v69, s[4:5]
    v_cndmask_b32 v66, v66, v70, s[4:5]
    v_cndmask_b32 v67, v67, v71, s[4:5]
    v_cndmask_b32 v72, v72, v76, s[4:5]
    v_cndmask_b32 v73, v73, v77, s[4:5]
    v_cndmask_b32 v74, v74, v78, s[4:5]
    v_cndmask_b32 v75, v75, v79, s[4:5]
    v_cndmask_b32 v48, v48, v56, s[6:7]
    v_cndmask_b32 v49, v49, v57, s[6:7]
    v_cndmask_b32 v50, v50, v58, s[6:7]
    v_cndmask_b32 v51, v51, v59, s[6:7]
    v_cndmask_b32 v64, v64, v72, s[6:7]
    v_cndmask_b32 v65, v65, v73, s[6:7]
    v_cndmask_b32 v66, v66, v74, s[6:7]
    v_cndmask_b32 v67, v67, v75, s[6:7]
    v_cndmask_b32 v24, v48, v64, s[8:9]
    v_cndmask_b32 v26, v49, v65, s[8:9]
    v_cndmask_b32 v28, v50, v66, s[8:9]
    v_cndmask_b32 v30, v51, v67, s[8:9]
    s_mov_b64 exec, s[10:11]
    buffer_store_dwordx2 v[24:25], v46, s[64:67], s72 offen offset:0 sc1
    buffer_store_dwordx2 v[26:27], v46, s[64:67], s72 offen offset:128 sc1
    buffer_store_dwordx2 v[28:29], v46, s[64:67], s72 offen offset:256 sc1
    buffer_store_dwordx2 v[30:31], v46, s[64:67], s72 offen offset:384 sc1
    s_mov_b64 exec, -1
    s_branch L_finish
L_gather:
    s_sub_u32 s73, s3, 4
    s_cmp_lt_u32 s68, 64
    s_cbranch_scc0 L_gather_h
    s_lshr_b32 s76, s68, 2
    s_lshl_b32 s78, s73, 4
    s_add_u32 s78, s78, s76
    s_mul_i32 s78, s78, 17408
    s_add_u32 s20, s78, 786432
    s_add_u32 s21, s20, 2176
    s_add_u32 s22, s20, 4352
    s_add_u32 s23, s20, 6528
    s_add_u32 s24, s20, 8704
    s_add_u32 s25, s20, 10880
    s_add_u32 s26, s20, 13056
    s_add_u32 s27, s20, 15232
    s_and_b32 s79, s68, 3
    s_lshl_b32 s79, s79, 9
    v_lshl_add_u32 v7, v0, 3, s79
    s_bfe_u32 s79, s68, 0x10001
    s_lshl_b32 s79, s79, 4
    s_add_u32 s79, s79, 2048
    v_and_b32 v8, 7, v0
    v_mul_u32_u24 v8, 2176, v8
    v_add_u32 v8, s79, v8
    s_lshl_b32 s79, s73, 8
    v_lshl_add_u32 v6, v0, 1, s79
    s_mov_b32 s91, 1048576
    buffer_load_dwordx4 v[48:51], v8, s[64:67], s20 offen sc1
    buffer_load_dwordx2 v[52:53], v7, s[64:67], s20 offen sc1
    buffer_load_dwordx2 v[54:55], v7, s[64:67], s21 offen sc1
    buffer_load_dwordx2 v[56:57], v7, s[64:67], s22 offen sc1
    buffer_load_dwordx2 v[58:59], v7, s[64:67], s23 offen sc1
    buffer_load_dwordx2 v[60:61], v7, s[64:67], s24 offen sc1
    buffer_load_dwordx2 v[62:63], v7, s[64:67], s25 offen sc1
    buffer_load_dwordx2 v[64:65], v7, s[64:67], s26 offen sc1
    buffer_load_dwordx2 v[66:67], v7, s[64:67], s27 offen sc1
L_pollp:
    s_waitcnt vmcnt(0)
    v_xor_b32 v9, s90, v49
    v_xor_b32 v10, s90, v51
    v_xor_b32 v11, s90, v53
    v_or3_b32 v9, v9, v10, v11
    v_xor_b32 v10, s90, v55
    v_xor_b32 v11, s90, v57
    v_or3_b32 v9, v9, v10, v11
    v_xor_b32 v10, s90, v59
    v_xor_b32 v11, s90, v61
    v_or3_b32 v9, v9, v10, v11
    v_xor_b32 v10, s90, v63
    v_xor_b32 v11, s90, v65
    v_or3_b32 v9, v9, v10, v11
    v_xor_b32 v10, s90, v67
    v_or_b32 v9, v9, v10
    v_cmp_ne_u32 s[92:93], 0, v9
    s_nop 3
    s_cmp_eq_u64 s[92:93], 0
    s_cbranch_scc1 L_pollp_ok0
    s_sub_u32 s91, s91, 1
    s_cbranch_scc1 L_pollp_ok0
    buffer_load_dwordx4 v[48:51], v8, s[64:67], s20 offen sc1
    buffer_load_dwordx2 v[52:53], v7, s[64:67], s20 offen sc1
    buffer_load_dwordx2 v[54:55], v7, s[64:67], s21 offen sc1
    buffer_load_dwordx2 v[56:57], v7, s[64:67], s22 offen sc1
    buffer_load_dwordx2 v[58:59], v7, s[64:67], s23 offen sc1
    buffer_load_dwordx2 v[60:61], v7, s[64:67], s24 offen sc1
    buffer_load_dwordx2 v[62:63], v7, s[64:67], s25 offen sc1
    buffer_load_dwordx2 v[64:65], v7, s[64:67], s26 offen sc1
    buffer_load_dwordx2 v[66:67], v7, s[64:67], s27 offen sc1
    s_branch L_pollp
L_pollp_ok0:
    v_mov_b32 v2, v48
    s_nop 1
    v_max_f32_dpp v2, v2, v2 quad_perm:[1,0,3,2] row_mask:0xf bank_mask:0xf
    s_nop 1
    v_max_f32_dpp v2, v2, v2 quad_perm:[2,3,0,1] row_mask:0xf bank_mask:0xf
    s_nop 1
    v_max_f32_dpp v2, v2, v2 row_half_mirror row_mask:0xf bank_mask:0xf
    v_sub_f32 v3, v48, v2
    v_mul_f32 v3, s87, v3
    v_exp_f32 v3, v3
    s_nop 0
    v_mul_f32 v4, v3, v50
    s_nop 1
    v_add_f32_dpp v4, v4, v4 quad_perm:[1,0,3,2] row_mask:0xf bank_mask:0xf
    s_nop 1
    v_add_f32_dpp v4, v4, v4 quad_perm:[2,3,0,1] row_mask:0xf bank_mask:0xf
    s_nop 1
    v_add_f32_dpp v4, v4, v4 row_half_mirror row_mask:0xf bank_mask:0xf
    v_readlane_b32 s4, v3, 0
    v_readlane_b32 s5, v3, 1
    v_readlane_b32 s6, v3, 2
    v_readlane_b32 s7, v3, 3
    v_readlane_b32 s8, v3, 4
    v_readlane_b32 s9, v3, 5
    v_readlane_b32 s10, v3, 6
    v_readlane_b32 s11, v3, 7
    v_rcp_f32 v5, v4
    v_mul_f32 v2, s4, v52
    v_mul_f32 v9, s5, v54
    v_fmac_f32 v2, s6, v56
    v_fmac_f32 v9, s7, v58
    v_fmac_f32 v2, s8, v60
    v_fmac_f32 v9, s9, v62
    v_fmac_f32 v2, s10, v64
    v_fmac_f32 v9, s11, v66
L_pollp_done:
    v_add_f32 v3, v2, v9
    v_mul_f32 v9, v3, v5
    v_fma_f32 v3, -v9, v4, v3
    v_fma_f32 v3, v3, v5, v9
    v_cvt_pk_bf16_f32 v3, v3, v3
    ds_write_b16 v6, v3 offset:6720
    s_branch L_zdone
L_gather_h:
    s_sub_u32 s76, s68, 64
    s_mul_i32 s76, s76, 12288
    s_lshl_b32 s78, s73, 10
    s_add_u32 s78, s78, s76
    s_add_u32 s78, s78, 327680
    s_add_u32 s79, s78, 4096
    s_add_u32 s80, s78, 8192
    s_mov_b32 s91, 1048576
    buffer_load_dwordx4 v[48:51], v2, s[64:67], s78 offen offset:0 sc1
    buffer_load_dwordx4 v[52:55], v2, s[64:67], s78 offen offset:2048 sc1
    buffer_load_dwordx4 v[56:59], v2, s[64:67], s79 offen offset:0 sc1
    buffer_load_dwordx4 v[60:63], v2, s[64:67], s79 offen offset:2048 sc1
    buffer_load_dwordx4 v[64:67], v2, s[64:67], s80 offen offset:0 sc1
    buffer_load_dwordx4 v[68:71], v2, s[64:67], s80 offen offset:2048 sc1
L_pollh:
    s_waitcnt vmcnt(0)
    v_xor_b32 v9, s90, v49
    v_xor_b32 v10, s90, v51
    v_xor_b32 v11, s90, v53
    v_or3_b32 v9, v9, v10, v11
    v_xor_b32 v10, s90, v55
    v_xor_b32 v11, s90, v57
    v_or3_b32 v9, v9, v10, v11
    v_xor_b32 v10, s90, v59
    v_xor_b32 v11, s90, v61
    v_or3_b32 v9, v9, v10, v11
    v_xor_b32 v10, s90, v63
    v_xor_b32 v11, s90, v65
    v_or3_b32 v9, v9, v10, v11
    v_xor_b32 v10, s90, v67
    v_xor_b32 v11, s90, v69
    v_or3_b32 v9, v9, v10, v11
    v_xor_b32 v10, s90, v71
    v_or_b32 v9, v9, v10
    v_cmp_ne_u32 s[92:93], 0, v9
    s_nop 3
    s_cmp_eq_u64 s[92:93], 0
    s_cbranch_scc1 L_pollh_ok0
    s_sub_u32 s91, s91, 1
    s_cbranch_scc1 L_pollh_ok0
    s_sleep 1
    buffer_load_dwordx4 v[48:51], v2, s[64:67], s78 offen offset:0 sc1
    buffer_load_dwordx4 v[52:55], v2, s[64:67], s78 offen offset:2048 sc1
    buffer_load_dwordx4 v[56:59], v2, s[64:67], s79 offen offset:0 sc1
    buffer_load_dwordx4 v[60:63], v2, s[64:67], s79 offen offset:2048 sc1
    buffer_load_dwordx4 v[64:67], v2, s[64:67], s80 offen offset:0 sc1
    buffer_load_dwordx4 v[68:71], v2, s[64:67], s80 offen offset:2048 sc1
    s_branch L_pollh
L_pollh_ok0:
L_pollh_done:
    v_add_f32 v48, v48, v52
    v_add_f32 v48, v48, v56
    v_cvt_pk_bf16_f32 v48, v48, v48
    v_and_b32 v48, 0xffff0000, v48
    v_add_f32 v50, v50, v54
    v_add_f32 v50, v50, v58
    v_cvt_pk_bf16_f32 v50, v50, v50
    v_and_b32 v50, 0xffff0000, v50
    v_add_f32 v60, v60, v64
    v_add_f32 v60, v60, v68
    v_cvt_pk_bf16_f32 v60, v60, v60
    v_and_b32 v60, 0xffff0000, v60
    v_add_f32 v62, v62, v66
    v_add_f32 v62, v62, v70
    v_cvt_pk_bf16_f32 v62, v62, v62
    v_and_b32 v62, 0xffff0000, v62
    v_mov_b32 v11, 0x3d372713
    v_mul_f32 v10, v48, v48
    v_mul_f32 v10, v10, v48
    v_fma_f32 v10, v10, v11, v48
    v_mul_f32 v10, 0xc0135761, v10
    v_exp_f32 v10, v10
    s_nop 0
    v_add_f32 v10, 1.0, v10
    v_rcp_f32 v10, v10
    s_nop 0
    v_mul_f32 v48, v48, v10
    v_cvt_pk_bf16_f32 v48, v48, v48
    v_and_b32 v48, 0xffff0000, v48
    v_mul_f32 v48, v48, v60
    v_cvt_pk_bf16_f32 v48, v48, v48
    v_mul_f32 v10, v50, v50
    v_mul_f32 v10, v10, v50
    v_fma_f32 v10, v10, v11, v50
    v_mul_f32 v10, 0xc0135761, v10
    v_exp_f32 v10, v10
    s_nop 0
    v_add_f32 v10, 1.0, v10
    v_rcp_f32 v10, v10
    s_nop 0
    v_mul_f32 v50, v50, v10
    v_cvt_pk_bf16_f32 v50, v50, v50
    v_and_b32 v50, 0xffff0000, v50
    v_mul_f32 v50, v50, v62
    v_cvt_pk_bf16_f32 v50, v50, v50
    s_lshl_b32 s79, s73, 7
    v_lshl_add_u32 v6, v0, 1, s79
    ds_write_b16 v6, v48 offset:6720
    ds_write_b16 v6, v50 offset:6976
L_zdone:
    s_waitcnt lgkmcnt(0)
    s_barrier
    s_branch L_finish
L_notcomb:
    s_cmp_lt_u32 s12, 72
    s_cbranch_scc0 L_finish
    s_cmp_ge_u32 s3, 6
    s_cbranch_scc0 L_finish
    s_lshl_b32 s73, s12, 1
    s_add_u32 s73, s73, s3
    s_sub_u32 s73, s73, 6
    v_lshrrev_b32 v6, 2, v0
    v_mul_u32_u24 v6, 9216, v6
    v_and_b32 v7, 3, v0
    s_lshl_b32 s72, s73, 2
    v_add_u32 v7, s72, v7
    v_lshl_add_u32 v6, v7, 4, v6
    v_lshlrev_b32 v7, 1, v7
    buffer_load_ushort v2, v7, s[28:31], 0 offen
    buffer_load_ushort v3, v7, s[28:31], 0 offen offset:1152
    v_cmp_gt_u32 vcc, 16, v0
    v_mov_b32 v8, 1073741824
    s_nop 0
    v_cndmask_b32 v8, v8, v6, vcc
    s_mov_b32 s20, 1376256
    s_mov_b32 s21, 1523712
    s_mov_b32 s22, 1671168
    s_mov_b32 s23, 1818624
    s_mov_b32 s24, 1966080
    s_mov_b32 s25, 2113536
    s_mov_b32 s26, 2260992
    s_mov_b32 s91, 1048576
    buffer_load_dwordx4 v[16:19], v6, s[64:67], s24 offen sc1
    buffer_load_dwordx4 v[20:23], v6, s[64:67], s25 offen sc1
    buffer_load_dwordx4 v[24:27], v8, s[64:67], s26 offen sc1
L_pollf:
    s_waitcnt vmcnt(0)
    v_mov_b32 v9, s90
    v_cndmask_b32 v25, v9, v25, vcc
    v_cndmask_b32 v27, v9, v27, vcc
    v_xor_b32 v9, s90, v17
    v_xor_b32 v10, s90, v19
    v_xor_b32 v11, s90, v21
    v_or3_b32 v9, v9, v10, v11
    v_xor_b32 v10, s90, v23
    v_xor_b32 v11, s90, v25
    v_or3_b32 v9, v9, v10, v11
    v_xor_b32 v10, s90, v27
    v_or_b32 v9, v9, v10
    v_cmp_ne_u32 s[92:93], 0, v9
    s_nop 3
    s_cmp_eq_u64 s[92:93], 0
    s_cbranch_scc1 L_pollf_ok0
    s_sub_u32 s91, s91, 1
    s_cbranch_scc1 L_pollf_ok0
    s_sleep 2
    buffer_load_dwordx4 v[16:19], v6, s[64:67], s24 offen sc1
    buffer_load_dwordx4 v[20:23], v6, s[64:67], s25 offen sc1
    buffer_load_dwordx4 v[24:27], v8, s[64:67], s26 offen sc1
    s_branch L_pollf
L_pollf_ok0:
L_pollf_done:
    v_add_f32 v16, v16, v20
    v_add_f32 v18, v18, v22
    v_add_f32 v16, v16, v24
    v_add_f32 v18, v18, v26
    s_nop 1
    v_permlane32_swap_b32 v16, v18
    s_nop 1
    v_add_f32 v16, v16, v18
    s_nop 1
    v_add_f32_dpp v16, v16, v16 row_ror:4 row_mask:0xf bank_mask:0xf
    s_nop 1
    v_add_f32_dpp v16, v16, v16 row_ror:8 row_mask:0xf bank_mask:0xf
    v_mov_b32 v18, v16
    s_nop 1
    v_permlane16_swap_b32 v16, v18
    s_nop 1
    v_add_f32 v16, v16, v18
    v_cvt_pk_bf16_f32 v16, v16, v16
    v_and_b32 v16, 0xffff0000, v16
    v_cmp_gt_u32 vcc, 32, v0
    v_add_u32 v4, 1152, v7
    s_nop 0
    v_cndmask_b32 v2, v3, v2, vcc
    v_cndmask_b32 v7, v4, v7, vcc
    v_lshlrev_b32 v2, 16, v2
    s_mov_b32 s91, 1048576
    buffer_load_dwordx4 v[32:35], v6, s[64:67], s20 offen sc1
    buffer_load_dwordx4 v[36:39], v6, s[64:67], s21 offen sc1
    buffer_load_dwordx4 v[40:43], v6, s[64:67], s22 offen sc1
    buffer_load_dwordx4 v[44:47], v6, s[64:67], s23 offen sc1
L_polly:
    s_waitcnt vmcnt(0)
    v_xor_b32 v9, s90, v33
    v_xor_b32 v10, s90, v35
    v_xor_b32 v11, s90, v37
    v_or3_b32 v9, v9, v10, v11
    v_xor_b32 v10, s90, v39
    v_xor_b32 v11, s90, v41
    v_or3_b32 v9, v9, v10, v11
    v_xor_b32 v10, s90, v43
    v_xor_b32 v11, s90, v45
    v_or3_b32 v9, v9, v10, v11
    v_xor_b32 v10, s90, v47
    v_or_b32 v9, v9, v10
    v_cmp_ne_u32 s[92:93], 0, v9
    s_nop 3
    s_cmp_eq_u64 s[92:93], 0
    s_cbranch_scc1 L_polly_ok0
    s_sub_u32 s91, s91, 1
    s_cbranch_scc1 L_polly_ok0
    buffer_load_dwordx4 v[32:35], v6, s[64:67], s20 offen sc1
    buffer_load_dwordx4 v[36:39], v6, s[64:67], s21 offen sc1
    buffer_load_dwordx4 v[40:43], v6, s[64:67], s22 offen sc1
    buffer_load_dwordx4 v[44:47], v6, s[64:67], s23 offen sc1
    s_branch L_polly
L_polly_ok0:
    v_add_f32 v12, v32, v36
    v_add_f32 v13, v34, v38
    v_add_f32 v14, v40, v44
    v_add_f32 v15, v42, v46
L_polly_done:
    v_add_f32 v12, v12, v14
    v_add_f32 v13, v13, v15
    s_nop 1
    v_permlane32_swap_b32 v12, v13
    s_nop 1
    v_add_f32 v12, v12, v13
    s_nop 1
    v_add_f32_dpp v12, v12, v12 row_ror:4 row_mask:0xf bank_mask:0xf
    s_nop 1
    v_add_f32_dpp v12, v12, v12 row_ror:8 row_mask:0xf bank_mask:0xf
    v_mov_b32 v13, v12
    s_nop 1
    v_permlane16_swap_b32 v12, v13
    s_nop 1
    v_add_f32 v12, v12, v13
    v_cvt_pk_bf16_f32 v12, v12, v12
    v_and_b32 v12, 0xffff0000, v12
    v_add_f32 v2, v2, v12
    v_cvt_pk_bf16_f32 v2, v2, v2
    v_and_b32 v2, 0xffff0000, v2
    v_add_f32 v2, v2, v16
    v_cvt_pk_bf16_f32 v2, v2, v2
    s_mov_b32 exec_lo, 0xf
    s_mov_b32 exec_hi, 0xf
    buffer_store_short v2, v7, s[60:63], 0 offen
    s_cmp_eq_u32 s73, 0
    s_cbranch_scc0 L_noepoch
    s_sub_u32 s72, s90, 0x9e3779b8
    v_mov_b32 v4, s72
    v_mov_b32 v5, 0
    s_mov_b64 exec, 1
    buffer_store_dword v4, v5, s[64:67], 0 offen sc1
L_noepoch:
    s_mov_b64 exec, -1
L_finish:
L_end:
    s_endpgm
.section .rodata,"a"
.p2align 6
.amdhsa_kernel parallel_sum__gqa_block_cached__geglu_ffn__decode_kernel
.amdhsa_next_free_vgpr 224
.amdhsa_next_free_sgpr 102
.amdhsa_accum_offset 160
.amdhsa_group_segment_fixed_size 0
.amdhsa_kernarg_size 96
.amdhsa_user_sgpr_count 2
.amdhsa_user_sgpr_kernarg_segment_ptr 1
.amdhsa_system_sgpr_workgroup_id_x 1
.end_amdhsa_kernel
```
